```python
import torch

def _softmax(x, axis=-1):
    return torch.softmax(x, dim=axis)
def _gelu(x):
    return torch.nn.functional.gelu(x, approximate="tanh")
def _silu(x):
    return torch.nn.functional.silu(x)
def _sigmoid(x):
    return torch.sigmoid(x)
def _layernorm(x, axis=-1, eps=1e-5):
    m = x.mean(dim=axis, keepdim=True)
    v = x.var(dim=axis, keepdim=True, unbiased=False)
    return (x - m) / torch.sqrt(v + eps)
def _scatter_add(tgt, idx, src, axis=0):
    return tgt.clone().index_add_(axis, idx, src)
def _segment_sum(src, seg, n):
    out = torch.zeros((n,) + src.shape[1:], dtype=src.dtype)
    return out.index_add_(0, seg, src)
def _pad(x, pw):
    flat = tuple(v for pair in reversed(pw) for v in pair)
    return torch.nn.functional.pad(x, flat)

kernel_name = 'standalone__deep_cross_wide_deep__recsys'

def setup_inputs():

    _w = (lambda a: (lambda t: t.to(torch.bfloat16) if t.is_floating_point() else t)(torch.as_tensor(a)))
    B, F, D = 1024, 100, 128
    V, Nd = min(1000, 100000), 13
    Din = F * D
    H = 4 * D
    return {
        "idx": _w((lambda lo, hi, *s: torch.randint(lo, hi, s))(0, V, B, F).to(torch.int64)),
        "table": _w((lambda *s: torch.randn(*s, dtype=torch.bfloat16) * 1.6)(V, D) * 0.05),
        "x_wide": _w((lambda *s: torch.randn(*s, dtype=torch.bfloat16) * 1.6)(B, Nd)),
        "w_wide": _w((lambda *s: torch.randn(*s, dtype=torch.bfloat16) * 1.6)(Nd) * 0.05),
        "b_wide": _w((lambda *s: torch.randn(*s, dtype=torch.bfloat16) * 1.6)(1) * 0.01),
        "W1": _w((lambda *s: torch.randn(*s, dtype=torch.bfloat16) * 1.6)(Din, H) * (2.0 / Din) ** 0.5),
        "b1": _w((lambda *s: torch.randn(*s, dtype=torch.bfloat16) * 1.6)(H) * 0.01),
        "W2": _w((lambda *s: torch.randn(*s, dtype=torch.bfloat16) * 1.6)(H) * (1.0 / H) ** 0.5),
        "b2": _w((lambda *s: torch.randn(*s, dtype=torch.bfloat16) * 1.6)(1) * 0.01),
    }

def reference(idx, table, x_wide, w_wide, b_wide, W1, b1, W2, b2):
    emb = table[idx]
    deep_in = emb.reshape(emb.shape[0], -1)
    h = deep_in @ W1 + b1
    h = h * (lambda x, dt: x.to(dt))(h > 0, h.dtype)
    deep_logit = h @ W2 + b2
    wide_logit = x_wide @ w_wide + b_wide
    return _sigmoid(wide_logit + deep_logit)
```

```asm
; @launch grid=(256,1,1) block=(256,1,1) lds=149568
.amdgcn_target "amdgcn-amd-amdhsa--gfx950"
.text
.globl standalone__deep_cross_wide_deep__recsys_kernel
.p2align 8
.type standalone__deep_cross_wide_deep__recsys_kernel,@function
standalone__deep_cross_wide_deep__recsys_kernel:
    s_cmp_ge_u32 s2, 256
    s_cbranch_scc1 L_END
    s_load_dwordx16 s[24:39], s[0:1], 0
    s_load_dwordx8 s[40:47], s[0:1], 64
    s_getpc_b64 s[78:79]
L_PCREF:
    v_and_b32 v1, 63, v0
    v_lshrrev_b32 v8, 6, v0
    v_and_b32 v2, 15, v0
    v_readfirstlane_b32 s3, v8
    s_lshr_b32 s52, s2, 3
    s_lshl_b32 s60, s52, 2
    v_mov_b32 v13, 0x7ffffff0
    s_add_u32 s60, s60, s3
    v_lshlrev_b32 v8, 14, v1
    s_lshl_b32 s53, s60, 7
    v_add_u32 v8, s53, v8
    s_mov_b32 s53, L_CODE_END-L_PCREF
    v_cmp_gt_u32 vcc, s53, v8
    s_and_saveexec_b64 s[76:77], vcc
    s_cbranch_execz L_NOCT
    global_load_dword v250, v8, s[78:79]
L_NOCT:
    s_mov_b64 exec, s[76:77]
    v_lshrrev_b32 v3, 4, v1
    s_and_b32 s48, s2, 7
    s_and_b32 s49, s52, 3
    s_lshr_b32 s50, s52, 2
    s_lshl_b32 s51, s48, 2
    s_add_u32 s51, s51, s49
    s_movk_i32 s59, 80
    s_lshl_b32 s52, s49, 15
    s_lshl_b32 s53, s48, 7
    s_add_u32 s52, s52, s53
    s_lshl_b32 s53, s3, 19
    s_add_u32 s56, s52, s53
    s_add_u32 s53, s3, 96
    s_lshl_b32 s53, s53, 17
    s_add_u32 s57, s52, s53
    v_lshlrev_b32 v8, 7, v1
    v_cmp_gt_u32 vcc, 16, v1
    v_lshrrev_b32 v11, 1, v1
    v_mul_u32_u24 v11, 400, v11
    v_cndmask_b32 v253, v13, v8, vcc
    v_and_b32 v12, 1, v1
    v_mul_u32_u24 v12, 60, v12
    v_add_u32 v11, v11, v12
    v_cndmask_b32 v254, v13, v11, vcc
    v_lshlrev_b32 v8, 21, v3
    v_bfe_u32 v11, v1, 2, 2
    v_lshl_add_u32 v8, v11, 17, v8
    v_and_b32 v11, 3, v1
    v_lshl_add_u32 v8, v11, 10, v8
    v_bfe_u32 v10, v0, 3, 1
    v_cndmask_b32 v240, v13, v8, vcc
    v_cmp_gt_u32 vcc, 48, v1
    v_lshlrev_b32 v4, 13, v3
    v_lshl_add_u32 v4, v10, 10, v4
    v_cndmask_b32 v239, v13, v8, vcc
    v_cmp_gt_u32 vcc, 4, v1
    v_and_b32 v9, 7, v0
    v_lshl_add_u32 v4, v9, 4, v4
    v_cndmask_b32 v241, v13, v8, vcc
    v_add_u32 v5, 0x1000, v4
    v_lshrrev_b32 v8, 2, v1
    v_and_b32 v9, 3, v1
    v_lshlrev_b32 v9, 4, v9
    v_lshl_add_u32 v244, v8, 8, v9
    v_mad_u32_u24 v245, v8, s59, v9
    s_mul_i32 s52, s3, 20480
    v_add_u32 v245, s52, v245
    s_movk_i32 s53, 400
    v_mul_u32_u24 v243, s53, v8
    v_and_b32 v9, 3, v1
    v_xor_b32 v8, v3, v9
    v_lshl_add_u32 v243, v8, 4, v243
    v_mul_u32_u24 v242, s53, v1
    v_add_u32 v242, 384, v242
    s_waitcnt lgkmcnt(0)
    s_mov_b32 s8, s26
    s_and_b32 s9, s27, 0xffff
    s_mov_b32 s10, 256000
    s_mov_b32 s11, 0x00020000
    s_mov_b32 s68, s24
    s_and_b32 s69, s25, 0xffff
    s_mov_b32 s70, 409600
    s_mov_b32 s71, 0x00020000
    s_lshl_b32 s52, s60, 11
    buffer_load_dword v250, v253, s[8:11], s52 offen
    s_mul_i32 s52, s60, 3200
    buffer_load_dword v251, v254, s[68:71], s52 offen
    s_mov_b32 s4, s34
    s_and_b32 s5, s35, 0xffff
    s_mov_b32 s6, 13107200
    s_mov_b32 s7, 0x00020000
    s_lshl_b32 s52, s50, 12
    s_add_u32 s52, s52, s56
    buffer_load_dword v252, v240, s[4:7], s52 offen
    s_add_u32 s58, s56, 0
    buffer_load_dwordx4 v[160:163], v4, s[4:7], s58 offen offset:0
    buffer_load_dwordx4 v[164:167], v4, s[4:7], s58 offen offset:2048
    buffer_load_dwordx4 v[168:171], v5, s[4:7], s58 offen offset:0
    buffer_load_dwordx4 v[172:175], v5, s[4:7], s58 offen offset:2048
    s_mul_i32 s55, s50, 51200
    s_add_u32 s12, s24, s55
    s_addc_u32 s13, s25, 0
    s_and_b32 s13, s13, 0xffff
    s_mov_b32 s14, 51200
    s_mov_b32 s15, 0x00020000
    s_lshl_b32 s52, s3, 11
    s_mul_i32 s53, s3, 12800
    s_add_u32 m0, s52, 124928
    s_add_u32 s54, s53, 0
    buffer_load_dwordx4 v243, s[12:15], s54 offen lds
    s_add_u32 m0, s52, 125952
    s_add_u32 s54, s53, 6400
    buffer_load_dwordx4 v243, s[12:15], s54 offen lds
    s_lshl_b32 s53, s3, 16
    s_lshl_b32 s73, s49, 6
    s_add_u32 s53, s53, s73
    buffer_load_dwordx4 a[0:3], v244, s[8:11], s53 offen
    v_mov_b32 v23, 0x05040100
    v_mov_b32 v11, 0x03020706
    v_cmp_eq_u32 vcc, 1, v10
    v_lshlrev_b32 v6, 4, v3
    v_lshlrev_b32 v7, 4, v1
    v_cndmask_b32 v23, v23, v11, vcc
    v_bfe_u32 v8, v2, 2, 2
    v_xor_b32 v8, s3, v8
    v_lshlrev_b32 v8, 4, v8
    v_lshl_add_u32 v8, v2, 6, v8
    v_lshlrev_b32 v9, 4, v2
    s_add_u32 s53, s53, 4096
    buffer_load_dwordx4 a[4:7], v244, s[8:11], s53 offen
    s_lshl_b32 s52, s3, 1
    s_lshl_b32 s54, s3, 2
    s_add_u32 s72, s52, 0
    s_and_b32 s72, s72, 7
    s_lshl_b32 s55, s72, 10
    s_add_u32 s55, s55, 83968
    v_add_u32 v32, s55, v8
    s_lshl_b32 s55, s72, 8
    s_add_u32 s55, s55, s54
    s_add_u32 s55, s55, 81920
    v_add_u32 v40, s55, v9
    s_add_u32 s53, s53, 4096
    buffer_load_dwordx4 a[8:11], v244, s[8:11], s53 offen
    s_add_u32 s72, s52, 1
    s_and_b32 s72, s72, 7
    s_lshl_b32 s55, s72, 10
    s_add_u32 s55, s55, 83968
    v_add_u32 v33, s55, v8
    s_lshl_b32 s55, s72, 8
    s_add_u32 s55, s55, s54
    s_add_u32 s55, s55, 81920
    v_add_u32 v41, s55, v9
    s_add_u32 s72, s52, 2
    s_and_b32 s72, s72, 7
    s_add_u32 s53, s53, 4096
    buffer_load_dwordx4 a[12:15], v244, s[8:11], s53 offen
    s_lshl_b32 s55, s72, 10
    s_add_u32 s55, s55, 83968
    v_add_u32 v34, s55, v8
    s_lshl_b32 s55, s72, 8
    s_add_u32 s55, s55, s54
    s_add_u32 s55, s55, 81920
    v_add_u32 v42, s55, v9
    s_add_u32 s72, s52, 3
    s_and_b32 s72, s72, 7
    s_lshl_b32 s55, s72, 10
    s_add_u32 s55, s55, 83968
    s_add_u32 s53, s53, 4096
    buffer_load_dwordx4 a[16:19], v244, s[8:11], s53 offen
    v_add_u32 v35, s55, v8
    s_lshl_b32 s55, s72, 8
    s_add_u32 s55, s55, s54
    s_add_u32 s55, s55, 81920
    v_add_u32 v43, s55, v9
    s_add_u32 s72, s52, 4
    s_and_b32 s72, s72, 7
    s_lshl_b32 s55, s72, 10
    s_add_u32 s55, s55, 83968
    v_add_u32 v36, s55, v8
    s_lshl_b32 s55, s72, 8
    s_add_u32 s53, s53, 4096
    buffer_load_dwordx4 a[20:23], v244, s[8:11], s53 offen
    s_add_u32 s55, s55, s54
    s_add_u32 s55, s55, 81920
    v_add_u32 v44, s55, v9
    s_add_u32 s72, s52, 5
    s_and_b32 s72, s72, 7
    s_lshl_b32 s55, s72, 10
    s_add_u32 s55, s55, 83968
    v_add_u32 v37, s55, v8
    s_lshl_b32 s55, s72, 8
    s_add_u32 s55, s55, s54
    s_add_u32 s55, s55, 81920
    s_add_u32 s53, s53, 4096
    buffer_load_dwordx4 a[24:27], v244, s[8:11], s53 offen
    v_add_u32 v45, s55, v9
    s_add_u32 s72, s52, 6
    s_and_b32 s72, s72, 7
    s_lshl_b32 s55, s72, 10
    s_add_u32 s55, s55, 83968
    v_add_u32 v38, s55, v8
    s_lshl_b32 s55, s72, 8
    s_add_u32 s55, s55, s54
    s_add_u32 s55, s55, 81920
    v_add_u32 v46, s55, v9
    s_add_u32 s72, s52, 7
    s_waitcnt vmcnt(6)
    ds_write_b128 v245, a[0:3] offset:0
    s_add_u32 s53, s53, 4096
    buffer_load_dwordx4 a[28:31], v244, s[8:11], s53 offen
    s_and_b32 s72, s72, 7
    s_lshl_b32 s55, s72, 10
    s_add_u32 s55, s55, 83968
    v_add_u32 v39, s55, v8
    s_lshl_b32 s55, s72, 8
    s_add_u32 s55, s55, s54
    s_add_u32 s55, s55, 81920
    v_add_u32 v47, s55, v9
    s_add_u32 s52, s3, 1
    s_and_b32 s52, s52, 3
    s_mul_i32 s52, s52, 12288
    s_lshl_b32 s63, s50, 12
    s_add_u32 s63, s63, s56
    buffer_load_dword v252, v239, s[4:7], s63 offen
    s_waitcnt vmcnt(7)
    ds_write_b128 v245, a[4:7] offset:1280
    s_add_u32 s53, s53, 4096
    buffer_load_dwordx4 a[32:35], v244, s[8:11], s53 offen
    s_add_u32 s52, s52, 51200
    v_add_u32 v53, s52, v7
    s_add_u32 s52, s3, 2
    s_and_b32 s52, s52, 3
    s_mul_i32 s52, s52, 12288
    s_add_u32 s52, s52, 55296
    v_add_u32 v54, s52, v7
    s_add_u32 s52, s3, 3
    s_and_b32 s52, s52, 3
    s_mul_i32 s52, s52, 12288
    s_add_u32 s52, s52, 59392
    s_waitcnt vmcnt(7)
    ds_write_b128 v245, a[8:11] offset:2560
    s_add_u32 s53, s53, 4096
    buffer_load_dwordx4 a[36:39], v244, s[8:11], s53 offen
    v_add_u32 v55, s52, v7
    s_mul_i32 s52, s3, 12288
    s_add_u32 s52, s52, 51200
    v_add_u32 v56, s52, v7
    s_lshl_b32 s52, s50, 5
    v_lshlrev_b32 v52, 15, v3
    v_lshl_add_u32 v52, v2, 4, v52
    s_lshl_b32 s54, s3, 3
    s_add_u32 s54, s52, s54
    s_lshl_b32 s55, s54, 15
    s_lshl_b32 s72, s51, 10
    s_waitcnt vmcnt(7)
    ds_write_b128 v245, a[12:15] offset:3840
    s_add_u32 s53, s53, 4096
    buffer_load_dwordx4 a[40:43], v244, s[8:11], s53 offen
    s_add_u32 s72, s72, s55
    s_add_u32 s73, s72, 131072
    s_lshl_b32 s54, s54, 9
    s_lshr_b32 s55, s51, 3
    s_lshl_b32 s55, s55, 7
    s_add_u32 s54, s54, s55
    s_and_b32 s55, s51, 7
    s_lshl_b32 s55, s55, 2
    s_add_u32 s54, s54, s55
    s_add_u32 s99, s54, 8388608
    s_add_u32 s54, s52, s51
    s_waitcnt vmcnt(7)
    ds_write_b128 v245, a[16:19] offset:5120
    s_add_u32 s53, s53, 4096
    buffer_load_dwordx4 a[44:47], v244, s[8:11], s53 offen
    s_lshl_b32 s55, s54, 15
    s_lshl_b32 s61, s3, 13
    s_add_u32 s61, s61, s55
    s_add_u32 s62, s61, 4096
    s_lshl_b32 s55, s54, 2
    s_add_u32 s55, s55, s3
    s_lshl_b32 s55, s55, 7
    s_add_u32 s98, s55, 8388608
    v_cmp_gt_u32 vcc, 8, v1
    v_lshlrev_b32 v58, 2, v1
    v_lshlrev_b32 v59, 9, v1
    s_waitcnt vmcnt(7)
    ds_write_b128 v245, a[20:23] offset:6400
    s_add_u32 s53, s53, 4096
    buffer_load_dwordx4 a[48:51], v244, s[8:11], s53 offen
    v_cndmask_b32 v58, v13, v58, vcc
    v_cmp_gt_u32 vcc, 4, v1
    v_and_b32 v60, 7, v1
    v_lshlrev_b32 v60, 3, v60
    v_cndmask_b32 v59, v13, v59, vcc
    v_lshl_add_u32 v60, v3, 1, v60
    v_add_u32 v60, v60, v10
    s_lshl_b32 s55, s3, 7
    v_add_u32 v60, s55, v60
    v_lshlrev_b32 v60, 1, v60
    s_lshl_b32 s52, s50, 7
    s_waitcnt vmcnt(7)
    ds_write_b128 v245, a[24:27] offset:7680
    s_add_u32 s53, s53, 4096
    buffer_load_dwordx4 a[52:55], v244, s[8:11], s53 offen
    s_lshl_b32 s55, s51, 2
    s_add_u32 s52, s52, s55
    v_add_u32 v61, s52, v3
    v_lshlrev_b32 v57, 1, v61
    v_mul_u32_u24 v61, 13, v61
    v_min_u32 v63, 12, v2
    v_add_u32 v61, v61, v63
    v_lshlrev_b32 v61, 1, v61
    v_lshlrev_b32 v63, 1, v63
    v_mov_b32 v62, 0
    s_waitcnt vmcnt(7)
    ds_write_b128 v245, a[28:31] offset:8960
    s_add_u32 s53, s53, 4096
    buffer_load_dwordx4 a[56:59], v244, s[8:11], s53 offen
    s_waitcnt vmcnt(6)
    ds_write_b128 v245, a[32:35] offset:10240
    s_add_u32 s53, s53, 4096
    buffer_load_dwordx4 a[60:63], v244, s[8:11], s53 offen
    s_waitcnt vmcnt(6)
    ds_write_b128 v245, a[36:39] offset:11520
    s_add_u32 s58, s56, 131072
    buffer_load_dwordx4 v[176:179], v4, s[4:7], s58 offen offset:0
    buffer_load_dwordx4 v[180:183], v4, s[4:7], s58 offen offset:2048
    buffer_load_dwordx4 v[184:187], v5, s[4:7], s58 offen offset:0
    buffer_load_dwordx4 v[188:191], v5, s[4:7], s58 offen offset:2048
    v_mov_b32_dpp v48, v160 row_ror:8 row_mask:0xf bank_mask:0xf
    v_perm_b32 v96, v48, v160, v23
    v_mov_b32_dpp v49, v164 row_ror:8 row_mask:0xf bank_mask:0xf
    v_perm_b32 v97, v49, v164, v23
    v_mov_b32_dpp v50, v168 row_ror:8 row_mask:0xf bank_mask:0xf
    v_perm_b32 v98, v50, v168, v23
    s_waitcnt vmcnt(9)
    ds_write_b128 v245, a[40:43] offset:12800
    v_mov_b32_dpp v51, v172 row_ror:8 row_mask:0xf bank_mask:0xf
    v_perm_b32 v99, v51, v172, v23
    v_mov_b32_dpp v48, v161 row_ror:8 row_mask:0xf bank_mask:0xf
    v_perm_b32 v100, v48, v161, v23
    v_mov_b32_dpp v49, v165 row_ror:8 row_mask:0xf bank_mask:0xf
    v_perm_b32 v101, v49, v165, v23
    s_waitcnt vmcnt(8)
    ds_write_b128 v245, a[44:47] offset:14080
    v_mov_b32_dpp v50, v169 row_ror:8 row_mask:0xf bank_mask:0xf
    v_perm_b32 v102, v50, v169, v23
    v_mov_b32_dpp v51, v173 row_ror:8 row_mask:0xf bank_mask:0xf
    v_perm_b32 v103, v51, v173, v23
    v_mov_b32_dpp v48, v162 row_ror:8 row_mask:0xf bank_mask:0xf
    v_perm_b32 v104, v48, v162, v23
    s_waitcnt vmcnt(7)
    ds_write_b128 v245, a[48:51] offset:15360
    v_mov_b32_dpp v49, v166 row_ror:8 row_mask:0xf bank_mask:0xf
    v_perm_b32 v105, v49, v166, v23
    v_mov_b32_dpp v50, v170 row_ror:8 row_mask:0xf bank_mask:0xf
    v_perm_b32 v106, v50, v170, v23
    v_mov_b32_dpp v51, v174 row_ror:8 row_mask:0xf bank_mask:0xf
    v_perm_b32 v107, v51, v174, v23
    s_waitcnt vmcnt(6)
    ds_write_b128 v245, a[52:55] offset:16640
    v_mov_b32_dpp v48, v163 row_ror:8 row_mask:0xf bank_mask:0xf
    v_perm_b32 v108, v48, v163, v23
    v_mov_b32_dpp v49, v167 row_ror:8 row_mask:0xf bank_mask:0xf
    v_perm_b32 v109, v49, v167, v23
    v_mov_b32_dpp v50, v171 row_ror:8 row_mask:0xf bank_mask:0xf
    v_perm_b32 v110, v50, v171, v23
    s_waitcnt vmcnt(5)
    ds_write_b128 v245, a[56:59] offset:17920
    v_mov_b32_dpp v51, v175 row_ror:8 row_mask:0xf bank_mask:0xf
    v_perm_b32 v111, v51, v175, v23
    s_waitcnt vmcnt(4)
    ds_write_b128 v245, a[60:63] offset:19200
    s_mov_b32 s52, 201326592
    s_add_u32 s16, s46, s52
    s_addc_u32 s17, s47, 0
    s_and_b32 s17, s17, 0xffff
    s_mov_b32 s18, 9437184
    s_mov_b32 s19, 0x00020000
    s_mov_b32 s20, s44
    s_and_b32 s21, s45, 0xffff
    s_mov_b32 s22, 256
    s_mov_b32 s23, 0x00020000
    s_mov_b32 s64, s42
    s_and_b32 s65, s43, 0xffff
    s_mov_b32 s66, 2048
    s_mov_b32 s67, 0x00020000
    s_waitcnt lgkmcnt(0)
    s_barrier
    ds_read_b128 v[128:131], v32 offset:40960
    ds_read_b128 v[132:135], v33 offset:40960
    ds_read_b128 v[136:139], v34 offset:40960
    ds_read_b128 v[140:143], v35 offset:40960
    ds_read_b128 v[144:147], v36 offset:40960
    ds_read_b128 v[148:151], v37 offset:40960
    ds_read_b128 v[152:155], v38 offset:40960
    ds_read_b128 v[156:159], v39 offset:40960
    s_lshl_b32 s52, s3, 11
    s_mul_i32 s53, s3, 12800
    s_add_u32 m0, s52, 116736
    s_add_u32 s54, s53, 64
    buffer_load_dwordx4 v243, s[12:15], s54 offen lds
    s_add_u32 m0, s52, 117760
    s_add_u32 s54, s53, 6464
    buffer_load_dwordx4 v243, s[12:15], s54 offen lds
    s_waitcnt lgkmcnt(7)
    v_mad_u32_u24 v24, v128, s59, v6
    ds_read_b128 a[96:99], v24
    s_waitcnt lgkmcnt(7)
    v_mad_u32_u24 v25, v132, s59, v6
    ds_read_b128 a[100:103], v25
    s_waitcnt lgkmcnt(7)
    v_mad_u32_u24 v26, v136, s59, v6
    ds_read_b128 a[104:107], v26
    s_waitcnt lgkmcnt(7)
    v_mad_u32_u24 v27, v140, s59, v6
    ds_read_b128 a[108:111], v27
    s_waitcnt lgkmcnt(7)
    v_mad_u32_u24 v28, v144, s59, v6
    ds_read_b128 a[112:115], v28
    s_waitcnt lgkmcnt(7)
    v_mad_u32_u24 v29, v148, s59, v6
    ds_read_b128 a[116:119], v29
    s_waitcnt lgkmcnt(7)
    v_mad_u32_u24 v30, v152, s59, v6
    ds_read_b128 a[120:123], v30
    s_waitcnt lgkmcnt(7)
    v_mad_u32_u24 v31, v156, s59, v6
    s_add_u32 s58, s56, 262144
    buffer_load_dwordx4 v[192:195], v4, s[4:7], s58 offen offset:0
    buffer_load_dwordx4 v[196:199], v4, s[4:7], s58 offen offset:2048
    buffer_load_dwordx4 v[200:203], v5, s[4:7], s58 offen offset:0
    buffer_load_dwordx4 v[204:207], v5, s[4:7], s58 offen offset:2048
    s_or_b32 s52, s2, s3
    s_cmp_lg_u32 s52, 0
    s_cbranch_scc1 L_NONONCE
    s_memrealtime s[54:55]
    s_waitcnt lgkmcnt(0)
    s_or_b32 s54, s54, 0x80000000
    v_mov_b32 v8, s54
    s_mov_b64 s[76:77], exec
    s_mov_b64 exec, 1
    buffer_store_dword v8, v62, s[20:23], 0 offen sc1
    s_mov_b64 exec, s[76:77]
L_NONONCE:
    s_waitcnt vmcnt(6) lgkmcnt(5)
    v_mfma_f32_16x16x32_bf16 v[64:67], a[96:99], v[96:99], 0
    ds_read_b128 a[124:127], v31
    v_mad_u32_u24 v24, v129, s59, v6
    v_mfma_f32_16x16x32_bf16 v[68:71], a[96:99], v[100:103], 0
    v_mov_b32_dpp v48, v176 row_ror:8 row_mask:0xf bank_mask:0xf
    s_add_u32 s58, s56, 393216
    v_mfma_f32_16x16x32_bf16 v[72:75], a[96:99], v[104:107], 0
    v_mov_b32_dpp v49, v180 row_ror:8 row_mask:0xf bank_mask:0xf
    v_perm_b32 v112, v48, v176, v23
    v_mfma_f32_16x16x32_bf16 v[76:79], a[96:99], v[108:111], 0
    buffer_load_dwordx4 v[208:211], v4, s[4:7], s58 offen offset:0
    v_mfma_f32_16x16x32_bf16 v[80:83], a[100:103], v[96:99], 0
    ds_read_b128 a[96:99], v24
    v_mad_u32_u24 v25, v133, s59, v6
    v_mfma_f32_16x16x32_bf16 v[84:87], a[100:103], v[100:103], 0
    v_mov_b32_dpp v50, v184 row_ror:8 row_mask:0xf bank_mask:0xf
    v_perm_b32 v113, v49, v180, v23
    v_mfma_f32_16x16x32_bf16 v[88:91], a[100:103], v[104:107], 0
    v_mov_b32_dpp v51, v188 row_ror:8 row_mask:0xf bank_mask:0xf
    v_perm_b32 v114, v50, v184, v23
    v_mfma_f32_16x16x32_bf16 v[92:95], a[100:103], v[108:111], 0
    buffer_load_dwordx4 v[212:215], v4, s[4:7], s58 offen offset:2048
    s_waitcnt lgkmcnt(5)
    v_mfma_f32_16x16x32_bf16 a[0:3], a[104:107], v[96:99], 0
    ds_read_b128 a[100:103], v25
    v_mad_u32_u24 v26, v137, s59, v6
    v_mfma_f32_16x16x32_bf16 a[4:7], a[104:107], v[100:103], 0
    v_mov_b32_dpp v48, v177 row_ror:8 row_mask:0xf bank_mask:0xf
    v_perm_b32 v115, v51, v188, v23
    v_mfma_f32_16x16x32_bf16 a[8:11], a[104:107], v[104:107], 0
    v_mov_b32_dpp v49, v181 row_ror:8 row_mask:0xf bank_mask:0xf
    v_perm_b32 v116, v48, v177, v23
    v_mfma_f32_16x16x32_bf16 a[12:15], a[104:107], v[108:111], 0
    buffer_load_dwordx4 v[216:219], v5, s[4:7], s58 offen offset:0
    s_waitcnt lgkmcnt(5)
    v_mfma_f32_16x16x32_bf16 a[16:19], a[108:111], v[96:99], 0
    ds_read_b128 a[104:107], v26
    v_mad_u32_u24 v27, v141, s59, v6
    v_mfma_f32_16x16x32_bf16 a[20:23], a[108:111], v[100:103], 0
    v_mov_b32_dpp v50, v185 row_ror:8 row_mask:0xf bank_mask:0xf
    v_perm_b32 v117, v49, v181, v23
    v_mfma_f32_16x16x32_bf16 a[24:27], a[108:111], v[104:107], 0
    v_mov_b32_dpp v51, v189 row_ror:8 row_mask:0xf bank_mask:0xf
    v_perm_b32 v118, v50, v185, v23
    v_mfma_f32_16x16x32_bf16 a[28:31], a[108:111], v[108:111], 0
    buffer_load_dwordx4 v[220:223], v5, s[4:7], s58 offen offset:2048
    s_add_u32 s58, s56, 2097152
    s_waitcnt lgkmcnt(3)
    v_mfma_f32_16x16x32_bf16 a[32:35], a[112:115], v[96:99], 0
    ds_read_b128 a[108:111], v27
    v_mad_u32_u24 v28, v145, s59, v6
    v_mfma_f32_16x16x32_bf16 a[36:39], a[112:115], v[100:103], 0
    v_mov_b32_dpp v48, v178 row_ror:8 row_mask:0xf bank_mask:0xf
    v_perm_b32 v119, v51, v189, v23
    v_mfma_f32_16x16x32_bf16 a[40:43], a[112:115], v[104:107], 0
    v_mov_b32_dpp v49, v182 row_ror:8 row_mask:0xf bank_mask:0xf
    v_perm_b32 v120, v48, v178, v23
    v_mfma_f32_16x16x32_bf16 a[44:47], a[112:115], v[108:111], 0
    buffer_load_dwordx4 v[160:163], v4, s[4:7], s58 offen offset:0
    s_lshl_b32 s52, s50, 12
    s_add_u32 s52, s52, s56
    v_mfma_f32_16x16x32_bf16 a[48:51], a[116:119], v[96:99], 0
    ds_read_b128 a[112:115], v28
    v_mad_u32_u24 v29, v149, s59, v6
    v_mfma_f32_16x16x32_bf16 a[52:55], a[116:119], v[100:103], 0
    v_mov_b32_dpp v50, v186 row_ror:8 row_mask:0xf bank_mask:0xf
    v_perm_b32 v121, v49, v182, v23
    v_mfma_f32_16x16x32_bf16 a[56:59], a[116:119], v[104:107], 0
    v_mov_b32_dpp v51, v190 row_ror:8 row_mask:0xf bank_mask:0xf
    v_perm_b32 v122, v50, v186, v23
    v_mfma_f32_16x16x32_bf16 a[60:63], a[116:119], v[108:111], 0
    buffer_load_dwordx4 v[164:167], v4, s[4:7], s58 offen offset:2048
    s_add_u32 s52, s52, 6291456
    v_mfma_f32_16x16x32_bf16 a[64:67], a[120:123], v[96:99], 0
    ds_read_b128 a[116:119], v29
    v_mad_u32_u24 v30, v153, s59, v6
    v_mfma_f32_16x16x32_bf16 a[68:71], a[120:123], v[100:103], 0
    v_mov_b32_dpp v48, v179 row_ror:8 row_mask:0xf bank_mask:0xf
    v_perm_b32 v123, v51, v190, v23
    v_mfma_f32_16x16x32_bf16 a[72:75], a[120:123], v[104:107], 0
    v_mov_b32_dpp v49, v183 row_ror:8 row_mask:0xf bank_mask:0xf
    v_perm_b32 v124, v48, v179, v23
    v_mfma_f32_16x16x32_bf16 a[76:79], a[120:123], v[108:111], 0
    buffer_load_dwordx4 v[168:171], v5, s[4:7], s58 offen offset:0
    v_mfma_f32_16x16x32_bf16 a[80:83], a[124:127], v[96:99], 0
    ds_read_b128 a[120:123], v30
    v_mad_u32_u24 v31, v157, s59, v6
    v_mfma_f32_16x16x32_bf16 a[84:87], a[124:127], v[100:103], 0
    v_mov_b32_dpp v50, v187 row_ror:8 row_mask:0xf bank_mask:0xf
    v_perm_b32 v125, v49, v183, v23
    v_mfma_f32_16x16x32_bf16 a[88:91], a[124:127], v[104:107], 0
    buffer_load_dwordx4 v[172:175], v5, s[4:7], s58 offen offset:2048
    v_mov_b32_dpp v51, v191 row_ror:8 row_mask:0xf bank_mask:0xf
    v_perm_b32 v126, v50, v187, v23
    v_mfma_f32_16x16x32_bf16 a[92:95], a[124:127], v[108:111], 0
    buffer_load_dword v254, v240, s[4:7], s52 offen
    v_perm_b32 v127, v51, v191, v23
    s_waitcnt vmcnt(9) lgkmcnt(3)
    v_mfma_f32_16x16x32_bf16 v[64:67], a[96:99], v[112:115], v[64:67]
    ds_read_b128 a[124:127], v31
    v_mad_u32_u24 v24, v130, s59, v6
    v_mfma_f32_16x16x32_bf16 v[68:71], a[96:99], v[116:119], v[68:71]
    v_mov_b32_dpp v48, v192 row_ror:8 row_mask:0xf bank_mask:0xf
    s_add_u32 s58, s56, 2228224
    v_mfma_f32_16x16x32_bf16 v[72:75], a[96:99], v[120:123], v[72:75]
    v_mov_b32_dpp v49, v196 row_ror:8 row_mask:0xf bank_mask:0xf
    v_perm_b32 v96, v48, v192, v23
    v_mfma_f32_16x16x32_bf16 v[76:79], a[96:99], v[124:127], v[76:79]
    buffer_load_dwordx4 v[176:179], v4, s[4:7], s58 offen offset:0
    v_mfma_f32_16x16x32_bf16 v[80:83], a[100:103], v[112:115], v[80:83]
    ds_read_b128 a[96:99], v24
    v_mad_u32_u24 v25, v134, s59, v6
    v_mfma_f32_16x16x32_bf16 v[84:87], a[100:103], v[116:119], v[84:87]
    v_mov_b32_dpp v50, v200 row_ror:8 row_mask:0xf bank_mask:0xf
    v_perm_b32 v97, v49, v196, v23
    v_mfma_f32_16x16x32_bf16 v[88:91], a[100:103], v[120:123], v[88:91]
    v_mov_b32_dpp v51, v204 row_ror:8 row_mask:0xf bank_mask:0xf
    v_perm_b32 v98, v50, v200, v23
    v_mfma_f32_16x16x32_bf16 v[92:95], a[100:103], v[124:127], v[92:95]
    buffer_load_dwordx4 v[180:183], v4, s[4:7], s58 offen offset:2048
    v_mfma_f32_16x16x32_bf16 a[0:3], a[104:107], v[112:115], a[0:3]
    ds_read_b128 a[100:103], v25
    v_mad_u32_u24 v26, v138, s59, v6
    v_mfma_f32_16x16x32_bf16 a[4:7], a[104:107], v[116:119], a[4:7]
    v_mov_b32_dpp v48, v193 row_ror:8 row_mask:0xf bank_mask:0xf
    v_perm_b32 v99, v51, v204, v23
    v_mfma_f32_16x16x32_bf16 a[8:11], a[104:107], v[120:123], a[8:11]
    v_mov_b32_dpp v49, v197 row_ror:8 row_mask:0xf bank_mask:0xf
    v_perm_b32 v100, v48, v193, v23
    v_mfma_f32_16x16x32_bf16 a[12:15], a[104:107], v[124:127], a[12:15]
    buffer_load_dwordx4 v[184:187], v5, s[4:7], s58 offen offset:0
    v_mfma_f32_16x16x32_bf16 a[16:19], a[108:111], v[112:115], a[16:19]
    ds_read_b128 a[104:107], v26
    v_mad_u32_u24 v27, v142, s59, v6
    v_mfma_f32_16x16x32_bf16 a[20:23], a[108:111], v[116:119], a[20:23]
    v_mov_b32_dpp v50, v201 row_ror:8 row_mask:0xf bank_mask:0xf
    v_perm_b32 v101, v49, v197, v23
    v_mfma_f32_16x16x32_bf16 a[24:27], a[108:111], v[120:123], a[24:27]
    v_mov_b32_dpp v51, v205 row_ror:8 row_mask:0xf bank_mask:0xf
    v_perm_b32 v102, v50, v201, v23
    v_mfma_f32_16x16x32_bf16 a[28:31], a[108:111], v[124:127], a[28:31]
    buffer_load_dwordx4 v[188:191], v5, s[4:7], s58 offen offset:2048
    s_waitcnt lgkmcnt(3)
    v_mfma_f32_16x16x32_bf16 a[32:35], a[112:115], v[112:115], a[32:35]
    ds_read_b128 a[108:111], v27
    v_mad_u32_u24 v28, v146, s59, v6
    v_mfma_f32_16x16x32_bf16 a[36:39], a[112:115], v[116:119], a[36:39]
    v_mov_b32_dpp v48, v194 row_ror:8 row_mask:0xf bank_mask:0xf
    v_perm_b32 v103, v51, v205, v23
    v_mfma_f32_16x16x32_bf16 a[40:43], a[112:115], v[120:123], a[40:43]
    v_mov_b32_dpp v49, v198 row_ror:8 row_mask:0xf bank_mask:0xf
    v_perm_b32 v104, v48, v194, v23
    v_mfma_f32_16x16x32_bf16 a[44:47], a[112:115], v[124:127], a[44:47]
    s_lshl_b32 s52, s3, 11
    s_mul_i32 s53, s3, 12800
    v_mfma_f32_16x16x32_bf16 a[48:51], a[116:119], v[112:115], a[48:51]
    ds_read_b128 a[112:115], v28
    v_mad_u32_u24 v29, v150, s59, v6
    v_mfma_f32_16x16x32_bf16 a[52:55], a[116:119], v[116:119], a[52:55]
    v_mov_b32_dpp v50, v202 row_ror:8 row_mask:0xf bank_mask:0xf
    v_perm_b32 v105, v49, v198, v23
    v_mfma_f32_16x16x32_bf16 a[56:59], a[116:119], v[120:123], a[56:59]
    v_mov_b32_dpp v51, v206 row_ror:8 row_mask:0xf bank_mask:0xf
    v_perm_b32 v106, v50, v202, v23
    v_mfma_f32_16x16x32_bf16 a[60:63], a[116:119], v[124:127], a[60:63]
    s_add_u32 m0, s52, 108544
    s_add_u32 s54, s53, 128
    v_mfma_f32_16x16x32_bf16 a[64:67], a[120:123], v[112:115], a[64:67]
    ds_read_b128 a[116:119], v29
    v_mad_u32_u24 v30, v154, s59, v6
    v_mfma_f32_16x16x32_bf16 a[68:71], a[120:123], v[116:119], a[68:71]
    v_mov_b32_dpp v48, v195 row_ror:8 row_mask:0xf bank_mask:0xf
    v_perm_b32 v107, v51, v206, v23
    v_mfma_f32_16x16x32_bf16 a[72:75], a[120:123], v[120:123], a[72:75]
    v_mov_b32_dpp v49, v199 row_ror:8 row_mask:0xf bank_mask:0xf
    v_perm_b32 v108, v48, v195, v23
    v_mfma_f32_16x16x32_bf16 a[76:79], a[120:123], v[124:127], a[76:79]
    buffer_load_dwordx4 v243, s[12:15], s54 offen lds
    s_add_u32 m0, s52, 109568
    s_add_u32 s54, s53, 6528
    v_mfma_f32_16x16x32_bf16 a[80:83], a[124:127], v[112:115], a[80:83]
    ds_read_b128 a[120:123], v30
    v_mad_u32_u24 v31, v158, s59, v6
    v_mfma_f32_16x16x32_bf16 a[84:87], a[124:127], v[116:119], a[84:87]
    v_mov_b32_dpp v50, v203 row_ror:8 row_mask:0xf bank_mask:0xf
    v_perm_b32 v109, v49, v199, v23
    v_mfma_f32_16x16x32_bf16 a[88:91], a[124:127], v[120:123], a[88:91]
    v_mov_b32_dpp v51, v207 row_ror:8 row_mask:0xf bank_mask:0xf
    v_perm_b32 v110, v50, v203, v23
    v_mfma_f32_16x16x32_bf16 a[92:95], a[124:127], v[124:127], a[92:95]
    buffer_load_dwordx4 v243, s[12:15], s54 offen lds
    v_perm_b32 v111, v51, v207, v23
    s_waitcnt vmcnt(11) lgkmcnt(3)
    v_mfma_f32_16x16x32_bf16 v[64:67], a[96:99], v[96:99], v[64:67]
    ds_read_b128 a[124:127], v31
    v_mad_u32_u24 v24, v131, s59, v6
    s_add_u32 s58, s56, 2359296
    v_mfma_f32_16x16x32_bf16 v[68:71], a[96:99], v[100:103], v[68:71]
    buffer_load_dwordx4 v[192:195], v4, s[4:7], s58 offen offset:0
    v_mov_b32_dpp v48, v208 row_ror:8 row_mask:0xf bank_mask:0xf
    v_mfma_f32_16x16x32_bf16 v[72:75], a[96:99], v[104:107], v[72:75]
    v_mov_b32_dpp v49, v212 row_ror:8 row_mask:0xf bank_mask:0xf
    v_perm_b32 v112, v48, v208, v23
    s_barrier
    v_mfma_f32_16x16x32_bf16 v[76:79], a[96:99], v[108:111], v[76:79]
    ds_read_b128 v[128:131], v32 offset:32768
    v_mfma_f32_16x16x32_bf16 v[80:83], a[100:103], v[96:99], v[80:83]
    ds_read_b128 a[96:99], v24
    v_mad_u32_u24 v25, v135, s59, v6
    v_mfma_f32_16x16x32_bf16 v[84:87], a[100:103], v[100:103], v[84:87]
    v_mov_b32_dpp v50, v216 row_ror:8 row_mask:0xf bank_mask:0xf
    v_perm_b32 v113, v49, v212, v23
    v_mfma_f32_16x16x32_bf16 v[88:91], a[100:103], v[104:107], v[88:91]
    v_mov_b32_dpp v51, v220 row_ror:8 row_mask:0xf bank_mask:0xf
    v_perm_b32 v114, v50, v216, v23
    v_mfma_f32_16x16x32_bf16 v[92:95], a[100:103], v[108:111], v[92:95]
    ds_read_b128 v[132:135], v33 offset:32768
    v_mfma_f32_16x16x32_bf16 a[0:3], a[104:107], v[96:99], a[0:3]
    ds_read_b128 a[100:103], v25
    v_mad_u32_u24 v26, v139, s59, v6
    v_mfma_f32_16x16x32_bf16 a[4:7], a[104:107], v[100:103], a[4:7]
    buffer_load_dwordx4 v[196:199], v4, s[4:7], s58 offen offset:2048
    v_mov_b32_dpp v48, v209 row_ror:8 row_mask:0xf bank_mask:0xf
    v_perm_b32 v115, v51, v220, v23
    v_mfma_f32_16x16x32_bf16 a[8:11], a[104:107], v[104:107], a[8:11]
    v_mov_b32_dpp v49, v213 row_ror:8 row_mask:0xf bank_mask:0xf
    v_perm_b32 v116, v48, v209, v23
    v_mfma_f32_16x16x32_bf16 a[12:15], a[104:107], v[108:111], a[12:15]
    ds_read_b128 v[136:139], v34 offset:32768
    v_mfma_f32_16x16x32_bf16 a[16:19], a[108:111], v[96:99], a[16:19]
    ds_read_b128 a[104:107], v26
    v_mad_u32_u24 v27, v143, s59, v6
    v_mfma_f32_16x16x32_bf16 a[20:23], a[108:111], v[100:103], a[20:23]
    v_mov_b32_dpp v50, v217 row_ror:8 row_mask:0xf bank_mask:0xf
    v_perm_b32 v117, v49, v213, v23
    v_mfma_f32_16x16x32_bf16 a[24:27], a[108:111], v[104:107], a[24:27]
    v_mov_b32_dpp v51, v221 row_ror:8 row_mask:0xf bank_mask:0xf
    v_perm_b32 v118, v50, v217, v23
    v_mfma_f32_16x16x32_bf16 a[28:31], a[108:111], v[108:111], a[28:31]
    ds_read_b128 v[140:143], v35 offset:32768
    s_waitcnt lgkmcnt(7)
    v_mfma_f32_16x16x32_bf16 a[32:35], a[112:115], v[96:99], a[32:35]
    ds_read_b128 a[108:111], v27
    v_mad_u32_u24 v28, v147, s59, v6
    v_mfma_f32_16x16x32_bf16 a[36:39], a[112:115], v[100:103], a[36:39]
    buffer_load_dwordx4 v[200:203], v5, s[4:7], s58 offen offset:0
    v_mov_b32_dpp v48, v210 row_ror:8 row_mask:0xf bank_mask:0xf
    v_perm_b32 v119, v51, v221, v23
    v_mfma_f32_16x16x32_bf16 a[40:43], a[112:115], v[104:107], a[40:43]
    v_mov_b32_dpp v49, v214 row_ror:8 row_mask:0xf bank_mask:0xf
    v_perm_b32 v120, v48, v210, v23
    v_mfma_f32_16x16x32_bf16 a[44:47], a[112:115], v[108:111], a[44:47]
    ds_read_b128 v[144:147], v36 offset:32768
    v_mfma_f32_16x16x32_bf16 a[48:51], a[116:119], v[96:99], a[48:51]
    ds_read_b128 a[112:115], v28
    v_mad_u32_u24 v29, v151, s59, v6
    v_mfma_f32_16x16x32_bf16 a[52:55], a[116:119], v[100:103], a[52:55]
    v_mov_b32_dpp v50, v218 row_ror:8 row_mask:0xf bank_mask:0xf
    v_perm_b32 v121, v49, v214, v23
    v_mfma_f32_16x16x32_bf16 a[56:59], a[116:119], v[104:107], a[56:59]
    v_mov_b32_dpp v51, v222 row_ror:8 row_mask:0xf bank_mask:0xf
    v_perm_b32 v122, v50, v218, v23
    v_mfma_f32_16x16x32_bf16 a[60:63], a[116:119], v[108:111], a[60:63]
    ds_read_b128 v[148:151], v37 offset:32768
    v_mfma_f32_16x16x32_bf16 a[64:67], a[120:123], v[96:99], a[64:67]
    ds_read_b128 a[116:119], v29
    v_mad_u32_u24 v30, v155, s59, v6
    v_mfma_f32_16x16x32_bf16 a[68:71], a[120:123], v[100:103], a[68:71]
    buffer_load_dwordx4 v[204:207], v5, s[4:7], s58 offen offset:2048
    v_mov_b32_dpp v48, v211 row_ror:8 row_mask:0xf bank_mask:0xf
    v_perm_b32 v123, v51, v222, v23
    v_mfma_f32_16x16x32_bf16 a[72:75], a[120:123], v[104:107], a[72:75]
    v_mov_b32_dpp v49, v215 row_ror:8 row_mask:0xf bank_mask:0xf
    v_perm_b32 v124, v48, v211, v23
    v_mfma_f32_16x16x32_bf16 a[76:79], a[120:123], v[108:111], a[76:79]
    ds_read_b128 v[152:155], v38 offset:32768
    v_mfma_f32_16x16x32_bf16 a[80:83], a[124:127], v[96:99], a[80:83]
    ds_read_b128 a[120:123], v30
    v_mad_u32_u24 v31, v159, s59, v6
    v_mfma_f32_16x16x32_bf16 a[84:87], a[124:127], v[100:103], a[84:87]
    v_mov_b32_dpp v50, v219 row_ror:8 row_mask:0xf bank_mask:0xf
    v_perm_b32 v125, v49, v215, v23
    v_mfma_f32_16x16x32_bf16 a[88:91], a[124:127], v[104:107], a[88:91]
    v_mov_b32_dpp v51, v223 row_ror:8 row_mask:0xf bank_mask:0xf
    v_perm_b32 v126, v50, v219, v23
    v_mfma_f32_16x16x32_bf16 a[92:95], a[124:127], v[108:111], a[92:95]
    ds_read_b128 v[156:159], v39 offset:32768
    v_perm_b32 v127, v51, v223, v23
    s_waitcnt vmcnt(11) lgkmcnt(7)
    v_mfma_f32_16x16x32_bf16 v[64:67], a[96:99], v[112:115], v[64:67]
    ds_read_b128 a[124:127], v31
    v_mad_u32_u24 v24, v128, s59, v6
    v_mfma_f32_16x16x32_bf16 v[68:71], a[96:99], v[116:119], v[68:71]
    v_mov_b32_dpp v48, v160 row_ror:8 row_mask:0xf bank_mask:0xf
    s_add_u32 s58, s56, 2490368
    v_mfma_f32_16x16x32_bf16 v[72:75], a[96:99], v[120:123], v[72:75]
    v_mov_b32_dpp v49, v164 row_ror:8 row_mask:0xf bank_mask:0xf
    v_perm_b32 v96, v48, v160, v23
    v_mfma_f32_16x16x32_bf16 v[76:79], a[96:99], v[124:127], v[76:79]
    buffer_load_dwordx4 v[208:211], v4, s[4:7], s58 offen offset:0
    v_mfma_f32_16x16x32_bf16 v[80:83], a[100:103], v[112:115], v[80:83]
    ds_read_b128 a[96:99], v24
    v_mad_u32_u24 v25, v132, s59, v6
    v_mfma_f32_16x16x32_bf16 v[84:87], a[100:103], v[116:119], v[84:87]
    v_mov_b32_dpp v50, v168 row_ror:8 row_mask:0xf bank_mask:0xf
    v_perm_b32 v97, v49, v164, v23
    v_mfma_f32_16x16x32_bf16 v[88:91], a[100:103], v[120:123], v[88:91]
    v_mov_b32_dpp v51, v172 row_ror:8 row_mask:0xf bank_mask:0xf
    v_perm_b32 v98, v50, v168, v23
    v_mfma_f32_16x16x32_bf16 v[92:95], a[100:103], v[124:127], v[92:95]
    buffer_load_dwordx4 v[212:215], v4, s[4:7], s58 offen offset:2048
    v_mfma_f32_16x16x32_bf16 a[0:3], a[104:107], v[112:115], a[0:3]
    ds_read_b128 a[100:103], v25
    v_mad_u32_u24 v26, v136, s59, v6
    v_mfma_f32_16x16x32_bf16 a[4:7], a[104:107], v[116:119], a[4:7]
    v_mov_b32_dpp v48, v161 row_ror:8 row_mask:0xf bank_mask:0xf
    v_perm_b32 v99, v51, v172, v23
    v_mfma_f32_16x16x32_bf16 a[8:11], a[104:107], v[120:123], a[8:11]
    v_mov_b32_dpp v49, v165 row_ror:8 row_mask:0xf bank_mask:0xf
    v_perm_b32 v100, v48, v161, v23
    v_mfma_f32_16x16x32_bf16 a[12:15], a[104:107], v[124:127], a[12:15]
    buffer_load_dwordx4 v[216:219], v5, s[4:7], s58 offen offset:0
    v_mfma_f32_16x16x32_bf16 a[16:19], a[108:111], v[112:115], a[16:19]
    ds_read_b128 a[104:107], v26
    v_mad_u32_u24 v27, v140, s59, v6
    v_mfma_f32_16x16x32_bf16 a[20:23], a[108:111], v[116:119], a[20:23]
    v_mov_b32_dpp v50, v169 row_ror:8 row_mask:0xf bank_mask:0xf
    v_perm_b32 v101, v49, v165, v23
    v_mfma_f32_16x16x32_bf16 a[24:27], a[108:111], v[120:123], a[24:27]
    v_mov_b32_dpp v51, v173 row_ror:8 row_mask:0xf bank_mask:0xf
    v_perm_b32 v102, v50, v169, v23
    v_mfma_f32_16x16x32_bf16 a[28:31], a[108:111], v[124:127], a[28:31]
    buffer_load_dwordx4 v[220:223], v5, s[4:7], s58 offen offset:2048
    s_waitcnt lgkmcnt(3)
    v_mfma_f32_16x16x32_bf16 a[32:35], a[112:115], v[112:115], a[32:35]
    ds_read_b128 a[108:111], v27
    v_mad_u32_u24 v28, v144, s59, v6
    v_mfma_f32_16x16x32_bf16 a[36:39], a[112:115], v[116:119], a[36:39]
    v_mov_b32_dpp v48, v162 row_ror:8 row_mask:0xf bank_mask:0xf
    v_perm_b32 v103, v51, v173, v23
    v_mfma_f32_16x16x32_bf16 a[40:43], a[112:115], v[120:123], a[40:43]
    v_mov_b32_dpp v49, v166 row_ror:8 row_mask:0xf bank_mask:0xf
    v_perm_b32 v104, v48, v162, v23
    v_mfma_f32_16x16x32_bf16 a[44:47], a[112:115], v[124:127], a[44:47]
    s_lshl_b32 s52, s3, 11
    s_mul_i32 s53, s3, 12800
    v_mfma_f32_16x16x32_bf16 a[48:51], a[116:119], v[112:115], a[48:51]
    ds_read_b128 a[112:115], v28
    v_mad_u32_u24 v29, v148, s59, v6
    v_mfma_f32_16x16x32_bf16 a[52:55], a[116:119], v[116:119], a[52:55]
    v_mov_b32_dpp v50, v170 row_ror:8 row_mask:0xf bank_mask:0xf
    v_perm_b32 v105, v49, v166, v23
    v_mfma_f32_16x16x32_bf16 a[56:59], a[116:119], v[120:123], a[56:59]
    v_mov_b32_dpp v51, v174 row_ror:8 row_mask:0xf bank_mask:0xf
    v_perm_b32 v106, v50, v170, v23
    v_mfma_f32_16x16x32_bf16 a[60:63], a[116:119], v[124:127], a[60:63]
    s_add_u32 m0, s52, 100352
    s_add_u32 s54, s53, 192
    v_mfma_f32_16x16x32_bf16 a[64:67], a[120:123], v[112:115], a[64:67]
    ds_read_b128 a[116:119], v29
    v_mad_u32_u24 v30, v152, s59, v6
    v_mfma_f32_16x16x32_bf16 a[68:71], a[120:123], v[116:119], a[68:71]
    v_mov_b32_dpp v48, v163 row_ror:8 row_mask:0xf bank_mask:0xf
    v_perm_b32 v107, v51, v174, v23
    v_mfma_f32_16x16x32_bf16 a[72:75], a[120:123], v[120:123], a[72:75]
    v_mov_b32_dpp v49, v167 row_ror:8 row_mask:0xf bank_mask:0xf
    v_perm_b32 v108, v48, v163, v23
    v_mfma_f32_16x16x32_bf16 a[76:79], a[120:123], v[124:127], a[76:79]
    buffer_load_dwordx4 v243, s[12:15], s54 offen lds
    s_add_u32 m0, s52, 101376
    s_add_u32 s54, s53, 6592
    v_mfma_f32_16x16x32_bf16 a[80:83], a[124:127], v[112:115], a[80:83]
    ds_read_b128 a[120:123], v30
    v_mad_u32_u24 v31, v156, s59, v6
    v_mfma_f32_16x16x32_bf16 a[84:87], a[124:127], v[116:119], a[84:87]
    v_mov_b32_dpp v50, v171 row_ror:8 row_mask:0xf bank_mask:0xf
    v_perm_b32 v109, v49, v167, v23
    v_mfma_f32_16x16x32_bf16 a[88:91], a[124:127], v[120:123], a[88:91]
    v_mov_b32_dpp v51, v175 row_ror:8 row_mask:0xf bank_mask:0xf
    v_perm_b32 v110, v50, v171, v23
    v_mfma_f32_16x16x32_bf16 a[92:95], a[124:127], v[124:127], a[92:95]
    buffer_load_dwordx4 v243, s[12:15], s54 offen lds
    v_perm_b32 v111, v51, v175, v23
    s_waitcnt vmcnt(12) lgkmcnt(3)
    v_mfma_f32_16x16x32_bf16 v[64:67], a[96:99], v[96:99], v[64:67]
    ds_read_b128 a[124:127], v31
    v_mad_u32_u24 v24, v129, s59, v6
    v_mfma_f32_16x16x32_bf16 v[68:71], a[96:99], v[100:103], v[68:71]
    v_mov_b32_dpp v48, v176 row_ror:8 row_mask:0xf bank_mask:0xf
    s_add_u32 s58, s56, 4194304
    v_mfma_f32_16x16x32_bf16 v[72:75], a[96:99], v[104:107], v[72:75]
    v_mov_b32_dpp v49, v180 row_ror:8 row_mask:0xf bank_mask:0xf
    v_perm_b32 v112, v48, v176, v23
    v_mfma_f32_16x16x32_bf16 v[76:79], a[96:99], v[108:111], v[76:79]
    buffer_load_dwordx4 v[160:163], v4, s[4:7], s58 offen offset:0
    v_mfma_f32_16x16x32_bf16 v[80:83], a[100:103], v[96:99], v[80:83]
    ds_read_b128 a[96:99], v24
    v_mad_u32_u24 v25, v133, s59, v6
    v_mfma_f32_16x16x32_bf16 v[84:87], a[100:103], v[100:103], v[84:87]
    v_mov_b32_dpp v50, v184 row_ror:8 row_mask:0xf bank_mask:0xf
    v_perm_b32 v113, v49, v180, v23
    v_mfma_f32_16x16x32_bf16 v[88:91], a[100:103], v[104:107], v[88:91]
    v_mov_b32_dpp v51, v188 row_ror:8 row_mask:0xf bank_mask:0xf
    v_perm_b32 v114, v50, v184, v23
    v_mfma_f32_16x16x32_bf16 v[92:95], a[100:103], v[108:111], v[92:95]
    buffer_load_dwordx4 v[164:167], v4, s[4:7], s58 offen offset:2048
    v_mfma_f32_16x16x32_bf16 a[0:3], a[104:107], v[96:99], a[0:3]
    ds_read_b128 a[100:103], v25
    v_mad_u32_u24 v26, v137, s59, v6
    v_mfma_f32_16x16x32_bf16 a[4:7], a[104:107], v[100:103], a[4:7]
    v_mov_b32_dpp v48, v177 row_ror:8 row_mask:0xf bank_mask:0xf
    v_perm_b32 v115, v51, v188, v23
    v_mfma_f32_16x16x32_bf16 a[8:11], a[104:107], v[104:107], a[8:11]
    v_mov_b32_dpp v49, v181 row_ror:8 row_mask:0xf bank_mask:0xf
    v_perm_b32 v116, v48, v177, v23
    v_mfma_f32_16x16x32_bf16 a[12:15], a[104:107], v[108:111], a[12:15]
    buffer_load_dwordx4 v[168:171], v5, s[4:7], s58 offen offset:0
    v_mfma_f32_16x16x32_bf16 a[16:19], a[108:111], v[96:99], a[16:19]
    ds_read_b128 a[104:107], v26
    v_mad_u32_u24 v27, v141, s59, v6
    v_mfma_f32_16x16x32_bf16 a[20:23], a[108:111], v[100:103], a[20:23]
    v_mov_b32_dpp v50, v185 row_ror:8 row_mask:0xf bank_mask:0xf
    v_perm_b32 v117, v49, v181, v23
    v_mfma_f32_16x16x32_bf16 a[24:27], a[108:111], v[104:107], a[24:27]
    v_mov_b32_dpp v51, v189 row_ror:8 row_mask:0xf bank_mask:0xf
    v_perm_b32 v118, v50, v185, v23
    v_mfma_f32_16x16x32_bf16 a[28:31], a[108:111], v[108:111], a[28:31]
    buffer_load_dwordx4 v[172:175], v5, s[4:7], s58 offen offset:2048
    s_waitcnt lgkmcnt(3)
    v_mfma_f32_16x16x32_bf16 a[32:35], a[112:115], v[96:99], a[32:35]
    ds_read_b128 a[108:111], v27
    v_mad_u32_u24 v28, v145, s59, v6
    v_mfma_f32_16x16x32_bf16 a[36:39], a[112:115], v[100:103], a[36:39]
    v_mov_b32_dpp v48, v178 row_ror:8 row_mask:0xf bank_mask:0xf
    v_perm_b32 v119, v51, v189, v23
    v_mfma_f32_16x16x32_bf16 a[40:43], a[112:115], v[104:107], a[40:43]
    v_mov_b32_dpp v49, v182 row_ror:8 row_mask:0xf bank_mask:0xf
    v_perm_b32 v120, v48, v178, v23
    v_mfma_f32_16x16x32_bf16 a[44:47], a[112:115], v[108:111], a[44:47]
    s_lshl_b32 s52, s50, 12
    s_add_u32 s52, s52, s56
    v_mfma_f32_16x16x32_bf16 a[48:51], a[116:119], v[96:99], a[48:51]
    ds_read_b128 a[112:115], v28
    v_mad_u32_u24 v29, v149, s59, v6
    v_mfma_f32_16x16x32_bf16 a[52:55], a[116:119], v[100:103], a[52:55]
    v_mov_b32_dpp v50, v186 row_ror:8 row_mask:0xf bank_mask:0xf
    v_perm_b32 v121, v49, v182, v23
    v_mfma_f32_16x16x32_bf16 a[56:59], a[116:119], v[104:107], a[56:59]
    v_mov_b32_dpp v51, v190 row_ror:8 row_mask:0xf bank_mask:0xf
    v_perm_b32 v122, v50, v186, v23
    v_mfma_f32_16x16x32_bf16 a[60:63], a[116:119], v[108:111], a[60:63]
    s_add_u32 s52, s52, 8388608
    v_mfma_f32_16x16x32_bf16 a[64:67], a[120:123], v[96:99], a[64:67]
    ds_read_b128 a[116:119], v29
    v_mad_u32_u24 v30, v153, s59, v6
    v_mfma_f32_16x16x32_bf16 a[68:71], a[120:123], v[100:103], a[68:71]
    v_mov_b32_dpp v48, v179 row_ror:8 row_mask:0xf bank_mask:0xf
    v_perm_b32 v123, v51, v190, v23
    v_mfma_f32_16x16x32_bf16 a[72:75], a[120:123], v[104:107], a[72:75]
    v_mov_b32_dpp v49, v183 row_ror:8 row_mask:0xf bank_mask:0xf
    v_perm_b32 v124, v48, v179, v23
    v_mfma_f32_16x16x32_bf16 a[76:79], a[120:123], v[108:111], a[76:79]
    buffer_load_dword v254, v240, s[4:7], s52 offen
    v_mfma_f32_16x16x32_bf16 a[80:83], a[124:127], v[96:99], a[80:83]
    ds_read_b128 a[120:123], v30
    v_mad_u32_u24 v31, v157, s59, v6
    v_mfma_f32_16x16x32_bf16 a[84:87], a[124:127], v[100:103], a[84:87]
    v_mov_b32_dpp v50, v187 row_ror:8 row_mask:0xf bank_mask:0xf
    v_perm_b32 v125, v49, v183, v23
    v_mfma_f32_16x16x32_bf16 a[88:91], a[124:127], v[104:107], a[88:91]
    v_mov_b32_dpp v51, v191 row_ror:8 row_mask:0xf bank_mask:0xf
    v_perm_b32 v126, v50, v187, v23
    v_mfma_f32_16x16x32_bf16 a[92:95], a[124:127], v[108:111], a[92:95]
    v_perm_b32 v127, v51, v191, v23
    s_waitcnt vmcnt(11) lgkmcnt(3)
    v_mfma_f32_16x16x32_bf16 v[64:67], a[96:99], v[112:115], v[64:67]
    ds_read_b128 a[124:127], v31
    v_mad_u32_u24 v24, v130, s59, v6
    v_mfma_f32_16x16x32_bf16 v[68:71], a[96:99], v[116:119], v[68:71]
    v_mov_b32_dpp v48, v192 row_ror:8 row_mask:0xf bank_mask:0xf
    s_add_u32 s58, s56, 4325376
    v_mfma_f32_16x16x32_bf16 v[72:75], a[96:99], v[120:123], v[72:75]
    v_mov_b32_dpp v49, v196 row_ror:8 row_mask:0xf bank_mask:0xf
    v_perm_b32 v96, v48, v192, v23
    v_mfma_f32_16x16x32_bf16 v[76:79], a[96:99], v[124:127], v[76:79]
    buffer_load_dwordx4 v[176:179], v4, s[4:7], s58 offen offset:0
    v_mfma_f32_16x16x32_bf16 v[80:83], a[100:103], v[112:115], v[80:83]
    ds_read_b128 a[96:99], v24
    v_mad_u32_u24 v25, v134, s59, v6
    v_mfma_f32_16x16x32_bf16 v[84:87], a[100:103], v[116:119], v[84:87]
    v_mov_b32_dpp v50, v200 row_ror:8 row_mask:0xf bank_mask:0xf
    v_perm_b32 v97, v49, v196, v23
    v_mfma_f32_16x16x32_bf16 v[88:91], a[100:103], v[120:123], v[88:91]
    v_mov_b32_dpp v51, v204 row_ror:8 row_mask:0xf bank_mask:0xf
    v_perm_b32 v98, v50, v200, v23
    v_mfma_f32_16x16x32_bf16 v[92:95], a[100:103], v[124:127], v[92:95]
    buffer_load_dwordx4 v[180:183], v4, s[4:7], s58 offen offset:2048
    v_mfma_f32_16x16x32_bf16 a[0:3], a[104:107], v[112:115], a[0:3]
    ds_read_b128 a[100:103], v25
    v_mad_u32_u24 v26, v138, s59, v6
    v_mfma_f32_16x16x32_bf16 a[4:7], a[104:107], v[116:119], a[4:7]
    v_mov_b32_dpp v48, v193 row_ror:8 row_mask:0xf bank_mask:0xf
    v_perm_b32 v99, v51, v204, v23
    v_mfma_f32_16x16x32_bf16 a[8:11], a[104:107], v[120:123], a[8:11]
    v_mov_b32_dpp v49, v197 row_ror:8 row_mask:0xf bank_mask:0xf
    v_perm_b32 v100, v48, v193, v23
    v_mfma_f32_16x16x32_bf16 a[12:15], a[104:107], v[124:127], a[12:15]
    buffer_load_dwordx4 v[184:187], v5, s[4:7], s58 offen offset:0
    v_mfma_f32_16x16x32_bf16 a[16:19], a[108:111], v[112:115], a[16:19]
    ds_read_b128 a[104:107], v26
    v_mad_u32_u24 v27, v142, s59, v6
    v_mfma_f32_16x16x32_bf16 a[20:23], a[108:111], v[116:119], a[20:23]
    v_mov_b32_dpp v50, v201 row_ror:8 row_mask:0xf bank_mask:0xf
    v_perm_b32 v101, v49, v197, v23
    v_mfma_f32_16x16x32_bf16 a[24:27], a[108:111], v[120:123], a[24:27]
    v_mov_b32_dpp v51, v205 row_ror:8 row_mask:0xf bank_mask:0xf
    v_perm_b32 v102, v50, v201, v23
    v_mfma_f32_16x16x32_bf16 a[28:31], a[108:111], v[124:127], a[28:31]
    buffer_load_dwordx4 v[188:191], v5, s[4:7], s58 offen offset:2048
    s_waitcnt lgkmcnt(3)
    v_mfma_f32_16x16x32_bf16 a[32:35], a[112:115], v[112:115], a[32:35]
    ds_read_b128 a[108:111], v27
    v_mad_u32_u24 v28, v146, s59, v6
    v_mfma_f32_16x16x32_bf16 a[36:39], a[112:115], v[116:119], a[36:39]
    v_mov_b32_dpp v48, v194 row_ror:8 row_mask:0xf bank_mask:0xf
    v_perm_b32 v103, v51, v205, v23
    v_mfma_f32_16x16x32_bf16 a[40:43], a[112:115], v[120:123], a[40:43]
    v_mov_b32_dpp v49, v198 row_ror:8 row_mask:0xf bank_mask:0xf
    v_perm_b32 v104, v48, v194, v23
    v_mfma_f32_16x16x32_bf16 a[44:47], a[112:115], v[124:127], a[44:47]
    v_mfma_f32_16x16x32_bf16 a[48:51], a[116:119], v[112:115], a[48:51]
    ds_read_b128 a[112:115], v28
    v_mad_u32_u24 v29, v150, s59, v6
    v_mfma_f32_16x16x32_bf16 a[52:55], a[116:119], v[116:119], a[52:55]
    v_mov_b32_dpp v50, v202 row_ror:8 row_mask:0xf bank_mask:0xf
    v_perm_b32 v105, v49, v198, v23
    v_mfma_f32_16x16x32_bf16 a[56:59], a[116:119], v[120:123], a[56:59]
    v_mov_b32_dpp v51, v206 row_ror:8 row_mask:0xf bank_mask:0xf
    v_perm_b32 v106, v50, v202, v23
    v_mfma_f32_16x16x32_bf16 a[60:63], a[116:119], v[124:127], a[60:63]
    v_mfma_f32_16x16x32_bf16 a[64:67], a[120:123], v[112:115], a[64:67]
    ds_read_b128 a[116:119], v29
    v_mad_u32_u24 v30, v154, s59, v6
    v_mfma_f32_16x16x32_bf16 a[68:71], a[120:123], v[116:119], a[68:71]
    v_mov_b32_dpp v48, v195 row_ror:8 row_mask:0xf bank_mask:0xf
    v_perm_b32 v107, v51, v206, v23
    v_mfma_f32_16x16x32_bf16 a[72:75], a[120:123], v[120:123], a[72:75]
    v_mov_b32_dpp v49, v199 row_ror:8 row_mask:0xf bank_mask:0xf
    v_perm_b32 v108, v48, v195, v23
    v_mfma_f32_16x16x32_bf16 a[76:79], a[120:123], v[124:127], a[76:79]
    v_mfma_f32_16x16x32_bf16 a[80:83], a[124:127], v[112:115], a[80:83]
    ds_read_b128 a[120:123], v30
    v_mad_u32_u24 v31, v158, s59, v6
    v_mfma_f32_16x16x32_bf16 a[84:87], a[124:127], v[116:119], a[84:87]
    v_mov_b32_dpp v50, v203 row_ror:8 row_mask:0xf bank_mask:0xf
    v_perm_b32 v109, v49, v199, v23
    v_mfma_f32_16x16x32_bf16 a[88:91], a[124:127], v[120:123], a[88:91]
    v_mov_b32_dpp v51, v207 row_ror:8 row_mask:0xf bank_mask:0xf
    v_perm_b32 v110, v50, v203, v23
    v_mfma_f32_16x16x32_bf16 a[92:95], a[124:127], v[124:127], a[92:95]
    v_perm_b32 v111, v51, v207, v23
    s_waitcnt vmcnt(11) lgkmcnt(3)
    v_mfma_f32_16x16x32_bf16 v[64:67], a[96:99], v[96:99], v[64:67]
    ds_read_b128 a[124:127], v31
    v_mad_u32_u24 v24, v131, s59, v6
    s_add_u32 s58, s56, 4456448
    v_mfma_f32_16x16x32_bf16 v[68:71], a[96:99], v[100:103], v[68:71]
    buffer_load_dwordx4 v[192:195], v4, s[4:7], s58 offen offset:0
    v_mov_b32_dpp v48, v208 row_ror:8 row_mask:0xf bank_mask:0xf
    v_mfma_f32_16x16x32_bf16 v[72:75], a[96:99], v[104:107], v[72:75]
    v_mov_b32_dpp v49, v212 row_ror:8 row_mask:0xf bank_mask:0xf
    v_perm_b32 v112, v48, v208, v23
    s_waitcnt vmcnt(10)
    s_barrier
    v_mfma_f32_16x16x32_bf16 v[76:79], a[96:99], v[108:111], v[76:79]
    ds_read_b128 v[128:131], v32 offset:24576
    v_mfma_f32_16x16x32_bf16 v[80:83], a[100:103], v[96:99], v[80:83]
    ds_read_b128 a[96:99], v24
    v_mad_u32_u24 v25, v135, s59, v6
    v_mfma_f32_16x16x32_bf16 v[84:87], a[100:103], v[100:103], v[84:87]
    v_mov_b32_dpp v50, v216 row_ror:8 row_mask:0xf bank_mask:0xf
    v_perm_b32 v113, v49, v212, v23
    v_mfma_f32_16x16x32_bf16 v[88:91], a[100:103], v[104:107], v[88:91]
    v_mov_b32_dpp v51, v220 row_ror:8 row_mask:0xf bank_mask:0xf
    v_perm_b32 v114, v50, v216, v23
    v_mfma_f32_16x16x32_bf16 v[92:95], a[100:103], v[108:111], v[92:95]
    ds_read_b128 v[132:135], v33 offset:24576
    v_mfma_f32_16x16x32_bf16 a[0:3], a[104:107], v[96:99], a[0:3]
    ds_read_b128 a[100:103], v25
    v_mad_u32_u24 v26, v139, s59, v6
    v_mfma_f32_16x16x32_bf16 a[4:7], a[104:107], v[100:103], a[4:7]
    buffer_load_dwordx4 v[196:199], v4, s[4:7], s58 offen offset:2048
    v_mov_b32_dpp v48, v209 row_ror:8 row_mask:0xf bank_mask:0xf
    v_perm_b32 v115, v51, v220, v23
    v_mfma_f32_16x16x32_bf16 a[8:11], a[104:107], v[104:107], a[8:11]
    v_mov_b32_dpp v49, v213 row_ror:8 row_mask:0xf bank_mask:0xf
    v_perm_b32 v116, v48, v209, v23
    v_mfma_f32_16x16x32_bf16 a[12:15], a[104:107], v[108:111], a[12:15]
    ds_read_b128 v[136:139], v34 offset:24576
    v_mfma_f32_16x16x32_bf16 a[16:19], a[108:111], v[96:99], a[16:19]
    ds_read_b128 a[104:107], v26
    v_mad_u32_u24 v27, v143, s59, v6
    v_mfma_f32_16x16x32_bf16 a[20:23], a[108:111], v[100:103], a[20:23]
    v_mov_b32_dpp v50, v217 row_ror:8 row_mask:0xf bank_mask:0xf
    v_perm_b32 v117, v49, v213, v23
    v_mfma_f32_16x16x32_bf16 a[24:27], a[108:111], v[104:107], a[24:27]
    v_mov_b32_dpp v51, v221 row_ror:8 row_mask:0xf bank_mask:0xf
    v_perm_b32 v118, v50, v217, v23
    v_mfma_f32_16x16x32_bf16 a[28:31], a[108:111], v[108:111], a[28:31]
    ds_read_b128 v[140:143], v35 offset:24576
    s_waitcnt lgkmcnt(7)
    v_mfma_f32_16x16x32_bf16 a[32:35], a[112:115], v[96:99], a[32:35]
    ds_read_b128 a[108:111], v27
    v_mad_u32_u24 v28, v147, s59, v6
    v_mfma_f32_16x16x32_bf16 a[36:39], a[112:115], v[100:103], a[36:39]
    buffer_load_dwordx4 v[200:203], v5, s[4:7], s58 offen offset:0
    v_mov_b32_dpp v48, v210 row_ror:8 row_mask:0xf bank_mask:0xf
    v_perm_b32 v119, v51, v221, v23
    v_mfma_f32_16x16x32_bf16 a[40:43], a[112:115], v[104:107], a[40:43]
    v_mov_b32_dpp v49, v214 row_ror:8 row_mask:0xf bank_mask:0xf
    v_perm_b32 v120, v48, v210, v23
    v_mfma_f32_16x16x32_bf16 a[44:47], a[112:115], v[108:111], a[44:47]
    ds_read_b128 v[144:147], v36 offset:24576
    v_mfma_f32_16x16x32_bf16 a[48:51], a[116:119], v[96:99], a[48:51]
    ds_read_b128 a[112:115], v28
    v_mad_u32_u24 v29, v151, s59, v6
    v_mfma_f32_16x16x32_bf16 a[52:55], a[116:119], v[100:103], a[52:55]
    v_mov_b32_dpp v50, v218 row_ror:8 row_mask:0xf bank_mask:0xf
    v_perm_b32 v121, v49, v214, v23
    v_mfma_f32_16x16x32_bf16 a[56:59], a[116:119], v[104:107], a[56:59]
    v_mov_b32_dpp v51, v222 row_ror:8 row_mask:0xf bank_mask:0xf
    v_perm_b32 v122, v50, v218, v23
    v_mfma_f32_16x16x32_bf16 a[60:63], a[116:119], v[108:111], a[60:63]
    ds_read_b128 v[148:151], v37 offset:24576
    v_mfma_f32_16x16x32_bf16 a[64:67], a[120:123], v[96:99], a[64:67]
    ds_read_b128 a[116:119], v29
    v_mad_u32_u24 v30, v155, s59, v6
    v_mfma_f32_16x16x32_bf16 a[68:71], a[120:123], v[100:103], a[68:71]
    buffer_load_dwordx4 v[204:207], v5, s[4:7], s58 offen offset:2048
    v_mov_b32_dpp v48, v211 row_ror:8 row_mask:0xf bank_mask:0xf
    v_perm_b32 v123, v51, v222, v23
    v_mfma_f32_16x16x32_bf16 a[72:75], a[120:123], v[104:107], a[72:75]
    v_mov_b32_dpp v49, v215 row_ror:8 row_mask:0xf bank_mask:0xf
    v_perm_b32 v124, v48, v211, v23
    v_mfma_f32_16x16x32_bf16 a[76:79], a[120:123], v[108:111], a[76:79]
    ds_read_b128 v[152:155], v38 offset:24576
    v_mfma_f32_16x16x32_bf16 a[80:83], a[124:127], v[96:99], a[80:83]
    ds_read_b128 a[120:123], v30
    v_mad_u32_u24 v31, v159, s59, v6
    v_mfma_f32_16x16x32_bf16 a[84:87], a[124:127], v[100:103], a[84:87]
    v_mov_b32_dpp v50, v219 row_ror:8 row_mask:0xf bank_mask:0xf
    v_perm_b32 v125, v49, v215, v23
    v_mfma_f32_16x16x32_bf16 a[88:91], a[124:127], v[104:107], a[88:91]
    v_mov_b32_dpp v51, v223 row_ror:8 row_mask:0xf bank_mask:0xf
    v_perm_b32 v126, v50, v219, v23
    v_mfma_f32_16x16x32_bf16 a[92:95], a[124:127], v[108:111], a[92:95]
    ds_read_b128 v[156:159], v39 offset:24576
    v_perm_b32 v127, v51, v223, v23
    s_waitcnt vmcnt(9) lgkmcnt(7)
    v_mfma_f32_16x16x32_bf16 v[64:67], a[96:99], v[112:115], v[64:67]
    ds_read_b128 a[124:127], v31
    v_mad_u32_u24 v24, v128, s59, v6
    v_mfma_f32_16x16x32_bf16 v[68:71], a[96:99], v[116:119], v[68:71]
    v_mov_b32_dpp v48, v160 row_ror:8 row_mask:0xf bank_mask:0xf
    s_add_u32 s58, s56, 4587520
    v_mfma_f32_16x16x32_bf16 v[72:75], a[96:99], v[120:123], v[72:75]
    v_mov_b32_dpp v49, v164 row_ror:8 row_mask:0xf bank_mask:0xf
    v_perm_b32 v96, v48, v160, v23
    v_mfma_f32_16x16x32_bf16 v[76:79], a[96:99], v[124:127], v[76:79]
    buffer_load_dwordx4 v[208:211], v4, s[4:7], s58 offen offset:0
    v_mfma_f32_16x16x32_bf16 v[80:83], a[100:103], v[112:115], v[80:83]
    ds_read_b128 a[96:99], v24
    v_mad_u32_u24 v25, v132, s59, v6
    v_mfma_f32_16x16x32_bf16 v[84:87], a[100:103], v[116:119], v[84:87]
    v_mov_b32_dpp v50, v168 row_ror:8 row_mask:0xf bank_mask:0xf
    v_perm_b32 v97, v49, v164, v23
    v_mfma_f32_16x16x32_bf16 v[88:91], a[100:103], v[120:123], v[88:91]
    v_mov_b32_dpp v51, v172 row_ror:8 row_mask:0xf bank_mask:0xf
    v_perm_b32 v98, v50, v168, v23
    v_mfma_f32_16x16x32_bf16 v[92:95], a[100:103], v[124:127], v[92:95]
    buffer_load_dwordx4 v[212:215], v4, s[4:7], s58 offen offset:2048
    v_mfma_f32_16x16x32_bf16 a[0:3], a[104:107], v[112:115], a[0:3]
    ds_read_b128 a[100:103], v25
    v_mad_u32_u24 v26, v136, s59, v6
    v_mfma_f32_16x16x32_bf16 a[4:7], a[104:107], v[116:119], a[4:7]
    v_mov_b32_dpp v48, v161 row_ror:8 row_mask:0xf bank_mask:0xf
    v_perm_b32 v99, v51, v172, v23
    v_mfma_f32_16x16x32_bf16 a[8:11], a[104:107], v[120:123], a[8:11]
    v_mov_b32_dpp v49, v165 row_ror:8 row_mask:0xf bank_mask:0xf
    v_perm_b32 v100, v48, v161, v23
    v_mfma_f32_16x16x32_bf16 a[12:15], a[104:107], v[124:127], a[12:15]
    buffer_load_dwordx4 v[216:219], v5, s[4:7], s58 offen offset:0
    v_mfma_f32_16x16x32_bf16 a[16:19], a[108:111], v[112:115], a[16:19]
    ds_read_b128 a[104:107], v26
    v_mad_u32_u24 v27, v140, s59, v6
    v_mfma_f32_16x16x32_bf16 a[20:23], a[108:111], v[116:119], a[20:23]
    v_mov_b32_dpp v50, v169 row_ror:8 row_mask:0xf bank_mask:0xf
    v_perm_b32 v101, v49, v165, v23
    v_mfma_f32_16x16x32_bf16 a[24:27], a[108:111], v[120:123], a[24:27]
    v_mov_b32_dpp v51, v173 row_ror:8 row_mask:0xf bank_mask:0xf
    v_perm_b32 v102, v50, v169, v23
    v_mfma_f32_16x16x32_bf16 a[28:31], a[108:111], v[124:127], a[28:31]
    buffer_load_dwordx4 v[220:223], v5, s[4:7], s58 offen offset:2048
    s_waitcnt lgkmcnt(3)
    v_mfma_f32_16x16x32_bf16 a[32:35], a[112:115], v[112:115], a[32:35]
    ds_read_b128 a[108:111], v27
    v_mad_u32_u24 v28, v144, s59, v6
    v_mfma_f32_16x16x32_bf16 a[36:39], a[112:115], v[116:119], a[36:39]
    v_mov_b32_dpp v48, v162 row_ror:8 row_mask:0xf bank_mask:0xf
    v_perm_b32 v103, v51, v173, v23
    v_mfma_f32_16x16x32_bf16 a[40:43], a[112:115], v[120:123], a[40:43]
    v_mov_b32_dpp v49, v166 row_ror:8 row_mask:0xf bank_mask:0xf
    v_perm_b32 v104, v48, v162, v23
    v_mfma_f32_16x16x32_bf16 a[44:47], a[112:115], v[124:127], a[44:47]
    s_lshl_b32 s52, s3, 11
    s_mul_i32 s53, s3, 12800
    v_mfma_f32_16x16x32_bf16 a[48:51], a[116:119], v[112:115], a[48:51]
    ds_read_b128 a[112:115], v28
    v_mad_u32_u24 v29, v148, s59, v6
    v_mfma_f32_16x16x32_bf16 a[52:55], a[116:119], v[116:119], a[52:55]
    v_mov_b32_dpp v50, v170 row_ror:8 row_mask:0xf bank_mask:0xf
    v_perm_b32 v105, v49, v166, v23
    v_mfma_f32_16x16x32_bf16 a[56:59], a[116:119], v[120:123], a[56:59]
    v_mov_b32_dpp v51, v174 row_ror:8 row_mask:0xf bank_mask:0xf
    v_perm_b32 v106, v50, v170, v23
    v_mfma_f32_16x16x32_bf16 a[60:63], a[116:119], v[124:127], a[60:63]
    s_add_u32 m0, s52, 92160
    s_add_u32 s54, s53, 256
    v_mfma_f32_16x16x32_bf16 a[64:67], a[120:123], v[112:115], a[64:67]
    ds_read_b128 a[116:119], v29
    v_mad_u32_u24 v30, v152, s59, v6
    v_mfma_f32_16x16x32_bf16 a[68:71], a[120:123], v[116:119], a[68:71]
    v_mov_b32_dpp v48, v163 row_ror:8 row_mask:0xf bank_mask:0xf
    v_perm_b32 v107, v51, v174, v23
    v_mfma_f32_16x16x32_bf16 a[72:75], a[120:123], v[120:123], a[72:75]
    v_mov_b32_dpp v49, v167 row_ror:8 row_mask:0xf bank_mask:0xf
    v_perm_b32 v108, v48, v163, v23
    v_mfma_f32_16x16x32_bf16 a[76:79], a[120:123], v[124:127], a[76:79]
    buffer_load_dwordx4 v243, s[12:15], s54 offen lds
    s_add_u32 m0, s52, 93184
    s_add_u32 s54, s53, 6656
    v_mfma_f32_16x16x32_bf16 a[80:83], a[124:127], v[112:115], a[80:83]
    ds_read_b128 a[120:123], v30
    v_mad_u32_u24 v31, v156, s59, v6
    v_mfma_f32_16x16x32_bf16 a[84:87], a[124:127], v[116:119], a[84:87]
    v_mov_b32_dpp v50, v171 row_ror:8 row_mask:0xf bank_mask:0xf
    v_perm_b32 v109, v49, v167, v23
    v_mfma_f32_16x16x32_bf16 a[88:91], a[124:127], v[120:123], a[88:91]
    v_mov_b32_dpp v51, v175 row_ror:8 row_mask:0xf bank_mask:0xf
    v_perm_b32 v110, v50, v171, v23
    v_mfma_f32_16x16x32_bf16 a[92:95], a[124:127], v[124:127], a[92:95]
    buffer_load_dwordx4 v243, s[12:15], s54 offen lds
    v_perm_b32 v111, v51, v175, v23
    s_waitcnt vmcnt(10) lgkmcnt(3)
    v_mfma_f32_16x16x32_bf16 v[64:67], a[96:99], v[96:99], v[64:67]
    ds_read_b128 a[124:127], v31
    v_mad_u32_u24 v24, v129, s59, v6
    v_mfma_f32_16x16x32_bf16 v[68:71], a[96:99], v[100:103], v[68:71]
    v_mov_b32_dpp v48, v176 row_ror:8 row_mask:0xf bank_mask:0xf
    s_add_u32 s58, s56, 6291456
    v_mfma_f32_16x16x32_bf16 v[72:75], a[96:99], v[104:107], v[72:75]
    v_mov_b32_dpp v49, v180 row_ror:8 row_mask:0xf bank_mask:0xf
    v_perm_b32 v112, v48, v176, v23
    v_mfma_f32_16x16x32_bf16 v[76:79], a[96:99], v[108:111], v[76:79]
    buffer_load_dwordx4 v[160:163], v4, s[4:7], s58 offen offset:0
    v_mfma_f32_16x16x32_bf16 v[80:83], a[100:103], v[96:99], v[80:83]
    ds_read_b128 a[96:99], v24
    v_mad_u32_u24 v25, v133, s59, v6
    v_mfma_f32_16x16x32_bf16 v[84:87], a[100:103], v[100:103], v[84:87]
    v_mov_b32_dpp v50, v184 row_ror:8 row_mask:0xf bank_mask:0xf
    v_perm_b32 v113, v49, v180, v23
    v_mfma_f32_16x16x32_bf16 v[88:91], a[100:103], v[104:107], v[88:91]
    v_mov_b32_dpp v51, v188 row_ror:8 row_mask:0xf bank_mask:0xf
    v_perm_b32 v114, v50, v184, v23
    v_mfma_f32_16x16x32_bf16 v[92:95], a[100:103], v[108:111], v[92:95]
    buffer_load_dwordx4 v[164:167], v4, s[4:7], s58 offen offset:2048
    v_mfma_f32_16x16x32_bf16 a[0:3], a[104:107], v[96:99], a[0:3]
    ds_read_b128 a[100:103], v25
    v_mad_u32_u24 v26, v137, s59, v6
    v_mfma_f32_16x16x32_bf16 a[4:7], a[104:107], v[100:103], a[4:7]
    v_mov_b32_dpp v48, v177 row_ror:8 row_mask:0xf bank_mask:0xf
    v_perm_b32 v115, v51, v188, v23
    v_mfma_f32_16x16x32_bf16 a[8:11], a[104:107], v[104:107], a[8:11]
    v_mov_b32_dpp v49, v181 row_ror:8 row_mask:0xf bank_mask:0xf
    v_perm_b32 v116, v48, v177, v23
    v_mfma_f32_16x16x32_bf16 a[12:15], a[104:107], v[108:111], a[12:15]
    buffer_load_dwordx4 v[168:171], v5, s[4:7], s58 offen offset:0
    v_mfma_f32_16x16x32_bf16 a[16:19], a[108:111], v[96:99], a[16:19]
    ds_read_b128 a[104:107], v26
    v_mad_u32_u24 v27, v141, s59, v6
    v_mfma_f32_16x16x32_bf16 a[20:23], a[108:111], v[100:103], a[20:23]
    v_mov_b32_dpp v50, v185 row_ror:8 row_mask:0xf bank_mask:0xf
    v_perm_b32 v117, v49, v181, v23
    v_mfma_f32_16x16x32_bf16 a[24:27], a[108:111], v[104:107], a[24:27]
    v_mov_b32_dpp v51, v189 row_ror:8 row_mask:0xf bank_mask:0xf
    v_perm_b32 v118, v50, v185, v23
    v_mfma_f32_16x16x32_bf16 a[28:31], a[108:111], v[108:111], a[28:31]
    buffer_load_dwordx4 v[172:175], v5, s[4:7], s58 offen offset:2048
    s_waitcnt lgkmcnt(3)
    v_mfma_f32_16x16x32_bf16 a[32:35], a[112:115], v[96:99], a[32:35]
    ds_read_b128 a[108:111], v27
    v_mad_u32_u24 v28, v145, s59, v6
    v_mfma_f32_16x16x32_bf16 a[36:39], a[112:115], v[100:103], a[36:39]
    v_mov_b32_dpp v48, v178 row_ror:8 row_mask:0xf bank_mask:0xf
    v_perm_b32 v119, v51, v189, v23
    v_mfma_f32_16x16x32_bf16 a[40:43], a[112:115], v[104:107], a[40:43]
    v_mov_b32_dpp v49, v182 row_ror:8 row_mask:0xf bank_mask:0xf
    v_perm_b32 v120, v48, v178, v23
    v_mfma_f32_16x16x32_bf16 a[44:47], a[112:115], v[108:111], a[44:47]
    s_lshl_b32 s52, s50, 12
    s_add_u32 s52, s52, s56
    v_mfma_f32_16x16x32_bf16 a[48:51], a[116:119], v[96:99], a[48:51]
    ds_read_b128 a[112:115], v28
    v_mad_u32_u24 v29, v149, s59, v6
    v_mfma_f32_16x16x32_bf16 a[52:55], a[116:119], v[100:103], a[52:55]
    v_mov_b32_dpp v50, v186 row_ror:8 row_mask:0xf bank_mask:0xf
    v_perm_b32 v121, v49, v182, v23
    v_mfma_f32_16x16x32_bf16 a[56:59], a[116:119], v[104:107], a[56:59]
    v_mov_b32_dpp v51, v190 row_ror:8 row_mask:0xf bank_mask:0xf
    v_perm_b32 v122, v50, v186, v23
    v_mfma_f32_16x16x32_bf16 a[60:63], a[116:119], v[108:111], a[60:63]
    s_add_u32 s52, s52, 10485760
    v_mfma_f32_16x16x32_bf16 a[64:67], a[120:123], v[96:99], a[64:67]
    ds_read_b128 a[116:119], v29
    v_mad_u32_u24 v30, v153, s59, v6
    v_mfma_f32_16x16x32_bf16 a[68:71], a[120:123], v[100:103], a[68:71]
    v_mov_b32_dpp v48, v179 row_ror:8 row_mask:0xf bank_mask:0xf
    v_perm_b32 v123, v51, v190, v23
    v_mfma_f32_16x16x32_bf16 a[72:75], a[120:123], v[104:107], a[72:75]
    v_mov_b32_dpp v49, v183 row_ror:8 row_mask:0xf bank_mask:0xf
    v_perm_b32 v124, v48, v179, v23
    v_mfma_f32_16x16x32_bf16 a[76:79], a[120:123], v[108:111], a[76:79]
    buffer_load_dword v254, v240, s[4:7], s52 offen
    v_mfma_f32_16x16x32_bf16 a[80:83], a[124:127], v[96:99], a[80:83]
    ds_read_b128 a[120:123], v30
    v_mad_u32_u24 v31, v157, s59, v6
    v_mfma_f32_16x16x32_bf16 a[84:87], a[124:127], v[100:103], a[84:87]
    v_mov_b32_dpp v50, v187 row_ror:8 row_mask:0xf bank_mask:0xf
    v_perm_b32 v125, v49, v183, v23
    v_mfma_f32_16x16x32_bf16 a[88:91], a[124:127], v[104:107], a[88:91]
    v_mov_b32_dpp v51, v191 row_ror:8 row_mask:0xf bank_mask:0xf
    v_perm_b32 v126, v50, v187, v23
    v_mfma_f32_16x16x32_bf16 a[92:95], a[124:127], v[108:111], a[92:95]
    v_perm_b32 v127, v51, v191, v23
    s_waitcnt vmcnt(11) lgkmcnt(3)
    v_mfma_f32_16x16x32_bf16 v[64:67], a[96:99], v[112:115], v[64:67]
    ds_read_b128 a[124:127], v31
    v_mad_u32_u24 v24, v130, s59, v6
    v_mfma_f32_16x16x32_bf16 v[68:71], a[96:99], v[116:119], v[68:71]
    v_mov_b32_dpp v48, v192 row_ror:8 row_mask:0xf bank_mask:0xf
    s_add_u32 s58, s56, 6422528
    v_mfma_f32_16x16x32_bf16 v[72:75], a[96:99], v[120:123], v[72:75]
    v_mov_b32_dpp v49, v196 row_ror:8 row_mask:0xf bank_mask:0xf
    v_perm_b32 v96, v48, v192, v23
    v_mfma_f32_16x16x32_bf16 v[76:79], a[96:99], v[124:127], v[76:79]
    buffer_load_dwordx4 v[176:179], v4, s[4:7], s58 offen offset:0
    v_mfma_f32_16x16x32_bf16 v[80:83], a[100:103], v[112:115], v[80:83]
    ds_read_b128 a[96:99], v24
    v_mad_u32_u24 v25, v134, s59, v6
    v_mfma_f32_16x16x32_bf16 v[84:87], a[100:103], v[116:119], v[84:87]
    v_mov_b32_dpp v50, v200 row_ror:8 row_mask:0xf bank_mask:0xf
    v_perm_b32 v97, v49, v196, v23
    v_mfma_f32_16x16x32_bf16 v[88:91], a[100:103], v[120:123], v[88:91]
    v_mov_b32_dpp v51, v204 row_ror:8 row_mask:0xf bank_mask:0xf
    v_perm_b32 v98, v50, v200, v23
    v_mfma_f32_16x16x32_bf16 v[92:95], a[100:103], v[124:127], v[92:95]
    buffer_load_dwordx4 v[180:183], v4, s[4:7], s58 offen offset:2048
    v_mfma_f32_16x16x32_bf16 a[0:3], a[104:107], v[112:115], a[0:3]
    ds_read_b128 a[100:103], v25
    v_mad_u32_u24 v26, v138, s59, v6
    v_mfma_f32_16x16x32_bf16 a[4:7], a[104:107], v[116:119], a[4:7]
    v_mov_b32_dpp v48, v193 row_ror:8 row_mask:0xf bank_mask:0xf
    v_perm_b32 v99, v51, v204, v23
    v_mfma_f32_16x16x32_bf16 a[8:11], a[104:107], v[120:123], a[8:11]
    v_mov_b32_dpp v49, v197 row_ror:8 row_mask:0xf bank_mask:0xf
    v_perm_b32 v100, v48, v193, v23
    v_mfma_f32_16x16x32_bf16 a[12:15], a[104:107], v[124:127], a[12:15]
    buffer_load_dwordx4 v[184:187], v5, s[4:7], s58 offen offset:0
    v_mfma_f32_16x16x32_bf16 a[16:19], a[108:111], v[112:115], a[16:19]
    ds_read_b128 a[104:107], v26
    v_mad_u32_u24 v27, v142, s59, v6
    v_mfma_f32_16x16x32_bf16 a[20:23], a[108:111], v[116:119], a[20:23]
    v_mov_b32_dpp v50, v201 row_ror:8 row_mask:0xf bank_mask:0xf
    v_perm_b32 v101, v49, v197, v23
    v_mfma_f32_16x16x32_bf16 a[24:27], a[108:111], v[120:123], a[24:27]
    v_mov_b32_dpp v51, v205 row_ror:8 row_mask:0xf bank_mask:0xf
    v_perm_b32 v102, v50, v201, v23
    v_mfma_f32_16x16x32_bf16 a[28:31], a[108:111], v[124:127], a[28:31]
    buffer_load_dwordx4 v[188:191], v5, s[4:7], s58 offen offset:2048
    s_waitcnt lgkmcnt(3)
    v_mfma_f32_16x16x32_bf16 a[32:35], a[112:115], v[112:115], a[32:35]
    ds_read_b128 a[108:111], v27
    v_mad_u32_u24 v28, v146, s59, v6
    v_mfma_f32_16x16x32_bf16 a[36:39], a[112:115], v[116:119], a[36:39]
    v_mov_b32_dpp v48, v194 row_ror:8 row_mask:0xf bank_mask:0xf
    v_perm_b32 v103, v51, v205, v23
    v_mfma_f32_16x16x32_bf16 a[40:43], a[112:115], v[120:123], a[40:43]
    v_mov_b32_dpp v49, v198 row_ror:8 row_mask:0xf bank_mask:0xf
    v_perm_b32 v104, v48, v194, v23
    v_mfma_f32_16x16x32_bf16 a[44:47], a[112:115], v[124:127], a[44:47]
    s_lshl_b32 s52, s3, 11
    s_mul_i32 s53, s3, 12800
    v_mfma_f32_16x16x32_bf16 a[48:51], a[116:119], v[112:115], a[48:51]
    ds_read_b128 a[112:115], v28
    v_mad_u32_u24 v29, v150, s59, v6
    v_mfma_f32_16x16x32_bf16 a[52:55], a[116:119], v[116:119], a[52:55]
    v_mov_b32_dpp v50, v202 row_ror:8 row_mask:0xf bank_mask:0xf
    v_perm_b32 v105, v49, v198, v23
    v_mfma_f32_16x16x32_bf16 a[56:59], a[116:119], v[120:123], a[56:59]
    v_mov_b32_dpp v51, v206 row_ror:8 row_mask:0xf bank_mask:0xf
    v_perm_b32 v106, v50, v202, v23
    v_mfma_f32_16x16x32_bf16 a[60:63], a[116:119], v[124:127], a[60:63]
    s_add_u32 m0, s52, 83968
    s_add_u32 s54, s53, 320
    v_mfma_f32_16x16x32_bf16 a[64:67], a[120:123], v[112:115], a[64:67]
    ds_read_b128 a[116:119], v29
    v_mad_u32_u24 v30, v154, s59, v6
    v_mfma_f32_16x16x32_bf16 a[68:71], a[120:123], v[116:119], a[68:71]
    v_mov_b32_dpp v48, v195 row_ror:8 row_mask:0xf bank_mask:0xf
    v_perm_b32 v107, v51, v206, v23
    v_mfma_f32_16x16x32_bf16 a[72:75], a[120:123], v[120:123], a[72:75]
    v_mov_b32_dpp v49, v199 row_ror:8 row_mask:0xf bank_mask:0xf
    v_perm_b32 v108, v48, v195, v23
    v_mfma_f32_16x16x32_bf16 a[76:79], a[120:123], v[124:127], a[76:79]
    buffer_load_dwordx4 v243, s[12:15], s54 offen lds
    s_add_u32 m0, s52, 84992
    s_add_u32 s54, s53, 6720
    v_mfma_f32_16x16x32_bf16 a[80:83], a[124:127], v[112:115], a[80:83]
    ds_read_b128 a[120:123], v30
    v_mad_u32_u24 v31, v158, s59, v6
    v_mfma_f32_16x16x32_bf16 a[84:87], a[124:127], v[116:119], a[84:87]
    v_mov_b32_dpp v50, v203 row_ror:8 row_mask:0xf bank_mask:0xf
    v_perm_b32 v109, v49, v199, v23
    v_mfma_f32_16x16x32_bf16 a[88:91], a[124:127], v[120:123], a[88:91]
    v_mov_b32_dpp v51, v207 row_ror:8 row_mask:0xf bank_mask:0xf
    v_perm_b32 v110, v50, v203, v23
    v_mfma_f32_16x16x32_bf16 a[92:95], a[124:127], v[124:127], a[92:95]
    buffer_load_dwordx4 v243, s[12:15], s54 offen lds
    v_perm_b32 v111, v51, v207, v23
    s_waitcnt vmcnt(13) lgkmcnt(3)
    v_mfma_f32_16x16x32_bf16 v[64:67], a[96:99], v[96:99], v[64:67]
    ds_read_b128 a[124:127], v31
    v_mad_u32_u24 v24, v131, s59, v6
    s_add_u32 s58, s56, 6553600
    v_mfma_f32_16x16x32_bf16 v[68:71], a[96:99], v[100:103], v[68:71]
    buffer_load_dwordx4 v[192:195], v4, s[4:7], s58 offen offset:0
    v_mov_b32_dpp v48, v208 row_ror:8 row_mask:0xf bank_mask:0xf
    v_mfma_f32_16x16x32_bf16 v[72:75], a[96:99], v[104:107], v[72:75]
    v_mov_b32_dpp v49, v212 row_ror:8 row_mask:0xf bank_mask:0xf
    v_perm_b32 v112, v48, v208, v23
    v_mfma_f32_16x16x32_bf16 v[76:79], a[96:99], v[108:111], v[76:79]
    ds_read_b128 v[128:131], v32 offset:16384
    v_mfma_f32_16x16x32_bf16 v[80:83], a[100:103], v[96:99], v[80:83]
    ds_read_b128 a[96:99], v24
    v_mad_u32_u24 v25, v135, s59, v6
    v_mfma_f32_16x16x32_bf16 v[84:87], a[100:103], v[100:103], v[84:87]
    v_mov_b32_dpp v50, v216 row_ror:8 row_mask:0xf bank_mask:0xf
    v_perm_b32 v113, v49, v212, v23
    v_mfma_f32_16x16x32_bf16 v[88:91], a[100:103], v[104:107], v[88:91]
    v_mov_b32_dpp v51, v220 row_ror:8 row_mask:0xf bank_mask:0xf
    v_perm_b32 v114, v50, v216, v23
    v_mfma_f32_16x16x32_bf16 v[92:95], a[100:103], v[108:111], v[92:95]
    ds_read_b128 v[132:135], v33 offset:16384
    v_mfma_f32_16x16x32_bf16 a[0:3], a[104:107], v[96:99], a[0:3]
    ds_read_b128 a[100:103], v25
    v_mad_u32_u24 v26, v139, s59, v6
    v_mfma_f32_16x16x32_bf16 a[4:7], a[104:107], v[100:103], a[4:7]
    buffer_load_dwordx4 v[196:199], v4, s[4:7], s58 offen offset:2048
    v_mov_b32_dpp v48, v209 row_ror:8 row_mask:0xf bank_mask:0xf
    v_perm_b32 v115, v51, v220, v23
    v_mfma_f32_16x16x32_bf16 a[8:11], a[104:107], v[104:107], a[8:11]
    v_mov_b32_dpp v49, v213 row_ror:8 row_mask:0xf bank_mask:0xf
    v_perm_b32 v116, v48, v209, v23
    v_mfma_f32_16x16x32_bf16 a[12:15], a[104:107], v[108:111], a[12:15]
    ds_read_b128 v[136:139], v34 offset:16384
    v_mfma_f32_16x16x32_bf16 a[16:19], a[108:111], v[96:99], a[16:19]
    ds_read_b128 a[104:107], v26
    v_mad_u32_u24 v27, v143, s59, v6
    v_mfma_f32_16x16x32_bf16 a[20:23], a[108:111], v[100:103], a[20:23]
    v_mov_b32_dpp v50, v217 row_ror:8 row_mask:0xf bank_mask:0xf
    v_perm_b32 v117, v49, v213, v23
    v_mfma_f32_16x16x32_bf16 a[24:27], a[108:111], v[104:107], a[24:27]
    v_mov_b32_dpp v51, v221 row_ror:8 row_mask:0xf bank_mask:0xf
    v_perm_b32 v118, v50, v217, v23
    v_mfma_f32_16x16x32_bf16 a[28:31], a[108:111], v[108:111], a[28:31]
    ds_read_b128 v[140:143], v35 offset:16384
    s_waitcnt lgkmcnt(7)
    v_mfma_f32_16x16x32_bf16 a[32:35], a[112:115], v[96:99], a[32:35]
    ds_read_b128 a[108:111], v27
    v_mad_u32_u24 v28, v147, s59, v6
    v_mfma_f32_16x16x32_bf16 a[36:39], a[112:115], v[100:103], a[36:39]
    buffer_load_dwordx4 v[200:203], v5, s[4:7], s58 offen offset:0
    v_mov_b32_dpp v48, v210 row_ror:8 row_mask:0xf bank_mask:0xf
    v_perm_b32 v119, v51, v221, v23
    v_mfma_f32_16x16x32_bf16 a[40:43], a[112:115], v[104:107], a[40:43]
    v_mov_b32_dpp v49, v214 row_ror:8 row_mask:0xf bank_mask:0xf
    v_perm_b32 v120, v48, v210, v23
    v_mfma_f32_16x16x32_bf16 a[44:47], a[112:115], v[108:111], a[44:47]
    ds_read_b128 v[144:147], v36 offset:16384
    v_mfma_f32_16x16x32_bf16 a[48:51], a[116:119], v[96:99], a[48:51]
    ds_read_b128 a[112:115], v28
    v_mad_u32_u24 v29, v151, s59, v6
    v_mfma_f32_16x16x32_bf16 a[52:55], a[116:119], v[100:103], a[52:55]
    v_mov_b32_dpp v50, v218 row_ror:8 row_mask:0xf bank_mask:0xf
    v_perm_b32 v121, v49, v214, v23
    v_mfma_f32_16x16x32_bf16 a[56:59], a[116:119], v[104:107], a[56:59]
    v_mov_b32_dpp v51, v222 row_ror:8 row_mask:0xf bank_mask:0xf
    v_perm_b32 v122, v50, v218, v23
    v_mfma_f32_16x16x32_bf16 a[60:63], a[116:119], v[108:111], a[60:63]
    ds_read_b128 v[148:151], v37 offset:16384
    v_mfma_f32_16x16x32_bf16 a[64:67], a[120:123], v[96:99], a[64:67]
    ds_read_b128 a[116:119], v29
    v_mad_u32_u24 v30, v155, s59, v6
    v_mfma_f32_16x16x32_bf16 a[68:71], a[120:123], v[100:103], a[68:71]
    buffer_load_dwordx4 v[204:207], v5, s[4:7], s58 offen offset:2048
    v_mov_b32_dpp v48, v211 row_ror:8 row_mask:0xf bank_mask:0xf
    v_perm_b32 v123, v51, v222, v23
    v_mfma_f32_16x16x32_bf16 a[72:75], a[120:123], v[104:107], a[72:75]
    v_mov_b32_dpp v49, v215 row_ror:8 row_mask:0xf bank_mask:0xf
    v_perm_b32 v124, v48, v211, v23
    v_mfma_f32_16x16x32_bf16 a[76:79], a[120:123], v[108:111], a[76:79]
    ds_read_b128 v[152:155], v38 offset:16384
    v_mfma_f32_16x16x32_bf16 a[80:83], a[124:127], v[96:99], a[80:83]
    ds_read_b128 a[120:123], v30
    v_mad_u32_u24 v31, v159, s59, v6
    v_mfma_f32_16x16x32_bf16 a[84:87], a[124:127], v[100:103], a[84:87]
    v_mov_b32_dpp v50, v219 row_ror:8 row_mask:0xf bank_mask:0xf
    v_perm_b32 v125, v49, v215, v23
    v_mfma_f32_16x16x32_bf16 a[88:91], a[124:127], v[104:107], a[88:91]
    v_mov_b32_dpp v51, v223 row_ror:8 row_mask:0xf bank_mask:0xf
    v_perm_b32 v126, v50, v219, v23
    v_mfma_f32_16x16x32_bf16 a[92:95], a[124:127], v[108:111], a[92:95]
    ds_read_b128 v[156:159], v39 offset:16384
    v_perm_b32 v127, v51, v223, v23
    s_waitcnt vmcnt(11) lgkmcnt(7)
    v_mfma_f32_16x16x32_bf16 v[64:67], a[96:99], v[112:115], v[64:67]
    ds_read_b128 a[124:127], v31
    v_mad_u32_u24 v24, v128, s59, v6
    v_mfma_f32_16x16x32_bf16 v[68:71], a[96:99], v[116:119], v[68:71]
    v_mov_b32_dpp v48, v160 row_ror:8 row_mask:0xf bank_mask:0xf
    s_add_u32 s58, s56, 6684672
    v_mfma_f32_16x16x32_bf16 v[72:75], a[96:99], v[120:123], v[72:75]
    v_mov_b32_dpp v49, v164 row_ror:8 row_mask:0xf bank_mask:0xf
    v_perm_b32 v96, v48, v160, v23
    v_mfma_f32_16x16x32_bf16 v[76:79], a[96:99], v[124:127], v[76:79]
    buffer_load_dwordx4 v[208:211], v4, s[4:7], s58 offen offset:0
    v_mfma_f32_16x16x32_bf16 v[80:83], a[100:103], v[112:115], v[80:83]
    ds_read_b128 a[96:99], v24
    v_mad_u32_u24 v25, v132, s59, v6
    v_mfma_f32_16x16x32_bf16 v[84:87], a[100:103], v[116:119], v[84:87]
    v_mov_b32_dpp v50, v168 row_ror:8 row_mask:0xf bank_mask:0xf
    v_perm_b32 v97, v49, v164, v23
    v_mfma_f32_16x16x32_bf16 v[88:91], a[100:103], v[120:123], v[88:91]
    v_mov_b32_dpp v51, v172 row_ror:8 row_mask:0xf bank_mask:0xf
    v_perm_b32 v98, v50, v168, v23
    v_mfma_f32_16x16x32_bf16 v[92:95], a[100:103], v[124:127], v[92:95]
    buffer_load_dwordx4 v[212:215], v4, s[4:7], s58 offen offset:2048
    v_mfma_f32_16x16x32_bf16 a[0:3], a[104:107], v[112:115], a[0:3]
    ds_read_b128 a[100:103], v25
    v_mad_u32_u24 v26, v136, s59, v6
    v_mfma_f32_16x16x32_bf16 a[4:7], a[104:107], v[116:119], a[4:7]
    v_mov_b32_dpp v48, v161 row_ror:8 row_mask:0xf bank_mask:0xf
    v_perm_b32 v99, v51, v172, v23
    v_mfma_f32_16x16x32_bf16 a[8:11], a[104:107], v[120:123], a[8:11]
    v_mov_b32_dpp v49, v165 row_ror:8 row_mask:0xf bank_mask:0xf
    v_perm_b32 v100, v48, v161, v23
    v_mfma_f32_16x16x32_bf16 a[12:15], a[104:107], v[124:127], a[12:15]
    buffer_load_dwordx4 v[216:219], v5, s[4:7], s58 offen offset:0
    v_mfma_f32_16x16x32_bf16 a[16:19], a[108:111], v[112:115], a[16:19]
    ds_read_b128 a[104:107], v26
    v_mad_u32_u24 v27, v140, s59, v6
    v_mfma_f32_16x16x32_bf16 a[20:23], a[108:111], v[116:119], a[20:23]
    v_mov_b32_dpp v50, v169 row_ror:8 row_mask:0xf bank_mask:0xf
    v_perm_b32 v101, v49, v165, v23
    v_mfma_f32_16x16x32_bf16 a[24:27], a[108:111], v[120:123], a[24:27]
    v_mov_b32_dpp v51, v173 row_ror:8 row_mask:0xf bank_mask:0xf
    v_perm_b32 v102, v50, v169, v23
    v_mfma_f32_16x16x32_bf16 a[28:31], a[108:111], v[124:127], a[28:31]
    buffer_load_dwordx4 v[220:223], v5, s[4:7], s58 offen offset:2048
    s_waitcnt lgkmcnt(3)
    v_mfma_f32_16x16x32_bf16 a[32:35], a[112:115], v[112:115], a[32:35]
    ds_read_b128 a[108:111], v27
    v_mad_u32_u24 v28, v144, s59, v6
    v_mfma_f32_16x16x32_bf16 a[36:39], a[112:115], v[116:119], a[36:39]
    v_mov_b32_dpp v48, v162 row_ror:8 row_mask:0xf bank_mask:0xf
    v_perm_b32 v103, v51, v173, v23
    v_mfma_f32_16x16x32_bf16 a[40:43], a[112:115], v[120:123], a[40:43]
    v_mov_b32_dpp v49, v166 row_ror:8 row_mask:0xf bank_mask:0xf
    v_perm_b32 v104, v48, v162, v23
    v_mfma_f32_16x16x32_bf16 a[44:47], a[112:115], v[124:127], a[44:47]
    s_and_b32 s52, s3, 1
    s_mul_i32 s53, s52, 25600
    v_mfma_f32_16x16x32_bf16 a[48:51], a[116:119], v[112:115], a[48:51]
    ds_read_b128 a[112:115], v28
    v_mad_u32_u24 v29, v148, s59, v6
    v_mfma_f32_16x16x32_bf16 a[52:55], a[116:119], v[116:119], a[52:55]
    v_mov_b32_dpp v50, v170 row_ror:8 row_mask:0xf bank_mask:0xf
    v_perm_b32 v105, v49, v166, v23
    v_mfma_f32_16x16x32_bf16 a[56:59], a[116:119], v[120:123], a[56:59]
    v_mov_b32_dpp v51, v174 row_ror:8 row_mask:0xf bank_mask:0xf
    v_perm_b32 v106, v50, v170, v23
    v_mfma_f32_16x16x32_bf16 a[60:63], a[116:119], v[124:127], a[60:63]
    s_lshl_b32 s52, s52, 10
    s_add_u32 m0, s52, 81920
    s_nop 0
    v_mfma_f32_16x16x32_bf16 a[64:67], a[120:123], v[112:115], a[64:67]
    ds_read_b128 a[116:119], v29
    v_mad_u32_u24 v30, v152, s59, v6
    v_mfma_f32_16x16x32_bf16 a[68:71], a[120:123], v[116:119], a[68:71]
    v_mov_b32_dpp v48, v163 row_ror:8 row_mask:0xf bank_mask:0xf
    v_perm_b32 v107, v51, v174, v23
    v_mfma_f32_16x16x32_bf16 a[72:75], a[120:123], v[120:123], a[72:75]
    v_mov_b32_dpp v49, v167 row_ror:8 row_mask:0xf bank_mask:0xf
    v_perm_b32 v108, v48, v163, v23
    v_mfma_f32_16x16x32_bf16 a[76:79], a[120:123], v[124:127], a[76:79]
    buffer_load_dwordx4 v242, s[12:15], s53 offen lds
    v_mfma_f32_16x16x32_bf16 a[80:83], a[124:127], v[112:115], a[80:83]
    ds_read_b128 a[120:123], v30
    v_mad_u32_u24 v31, v156, s59, v6
    v_mfma_f32_16x16x32_bf16 a[84:87], a[124:127], v[116:119], a[84:87]
    v_mov_b32_dpp v50, v171 row_ror:8 row_mask:0xf bank_mask:0xf
    v_perm_b32 v109, v49, v167, v23
    v_mfma_f32_16x16x32_bf16 a[88:91], a[124:127], v[120:123], a[88:91]
    v_mov_b32_dpp v51, v175 row_ror:8 row_mask:0xf bank_mask:0xf
    v_perm_b32 v110, v50, v171, v23
    v_mfma_f32_16x16x32_bf16 a[92:95], a[124:127], v[124:127], a[92:95]
    v_perm_b32 v111, v51, v175, v23
    s_waitcnt vmcnt(11) lgkmcnt(3)
    v_mfma_f32_16x16x32_bf16 v[64:67], a[96:99], v[96:99], v[64:67]
    ds_read_b128 a[124:127], v31
    v_mad_u32_u24 v24, v129, s59, v6
    v_mfma_f32_16x16x32_bf16 v[68:71], a[96:99], v[100:103], v[68:71]
    v_mov_b32_dpp v48, v176 row_ror:8 row_mask:0xf bank_mask:0xf
    s_add_u32 s58, s56, 8388608
    v_mfma_f32_16x16x32_bf16 v[72:75], a[96:99], v[104:107], v[72:75]
    v_mov_b32_dpp v49, v180 row_ror:8 row_mask:0xf bank_mask:0xf
    v_perm_b32 v112, v48, v176, v23
    v_mfma_f32_16x16x32_bf16 v[76:79], a[96:99], v[108:111], v[76:79]
    buffer_load_dwordx4 v[160:163], v4, s[4:7], s58 offen offset:0
    v_mfma_f32_16x16x32_bf16 v[80:83], a[100:103], v[96:99], v[80:83]
    ds_read_b128 a[96:99], v24
    v_mad_u32_u24 v25, v133, s59, v6
    v_mfma_f32_16x16x32_bf16 v[84:87], a[100:103], v[100:103], v[84:87]
    v_mov_b32_dpp v50, v184 row_ror:8 row_mask:0xf bank_mask:0xf
    v_perm_b32 v113, v49, v180, v23
    v_mfma_f32_16x16x32_bf16 v[88:91], a[100:103], v[104:107], v[88:91]
    v_mov_b32_dpp v51, v188 row_ror:8 row_mask:0xf bank_mask:0xf
    v_perm_b32 v114, v50, v184, v23
    v_mfma_f32_16x16x32_bf16 v[92:95], a[100:103], v[108:111], v[92:95]
    buffer_load_dwordx4 v[164:167], v4, s[4:7], s58 offen offset:2048
    v_mfma_f32_16x16x32_bf16 a[0:3], a[104:107], v[96:99], a[0:3]
    ds_read_b128 a[100:103], v25
    v_mad_u32_u24 v26, v137, s59, v6
    v_mfma_f32_16x16x32_bf16 a[4:7], a[104:107], v[100:103], a[4:7]
    v_mov_b32_dpp v48, v177 row_ror:8 row_mask:0xf bank_mask:0xf
    v_perm_b32 v115, v51, v188, v23
    v_mfma_f32_16x16x32_bf16 a[8:11], a[104:107], v[104:107], a[8:11]
    v_mov_b32_dpp v49, v181 row_ror:8 row_mask:0xf bank_mask:0xf
    v_perm_b32 v116, v48, v177, v23
    v_mfma_f32_16x16x32_bf16 a[12:15], a[104:107], v[108:111], a[12:15]
    buffer_load_dwordx4 v[168:171], v5, s[4:7], s58 offen offset:0
    v_mfma_f32_16x16x32_bf16 a[16:19], a[108:111], v[96:99], a[16:19]
    ds_read_b128 a[104:107], v26
    v_mad_u32_u24 v27, v141, s59, v6
    v_mfma_f32_16x16x32_bf16 a[20:23], a[108:111], v[100:103], a[20:23]
    v_mov_b32_dpp v50, v185 row_ror:8 row_mask:0xf bank_mask:0xf
    v_perm_b32 v117, v49, v181, v23
    v_mfma_f32_16x16x32_bf16 a[24:27], a[108:111], v[104:107], a[24:27]
    v_mov_b32_dpp v51, v189 row_ror:8 row_mask:0xf bank_mask:0xf
    v_perm_b32 v118, v50, v185, v23
    v_mfma_f32_16x16x32_bf16 a[28:31], a[108:111], v[108:111], a[28:31]
    buffer_load_dwordx4 v[172:175], v5, s[4:7], s58 offen offset:2048
    s_waitcnt lgkmcnt(3)
    v_mfma_f32_16x16x32_bf16 a[32:35], a[112:115], v[96:99], a[32:35]
    ds_read_b128 a[108:111], v27
    v_mad_u32_u24 v28, v145, s59, v6
    v_mfma_f32_16x16x32_bf16 a[36:39], a[112:115], v[100:103], a[36:39]
    v_mov_b32_dpp v48, v178 row_ror:8 row_mask:0xf bank_mask:0xf
    v_perm_b32 v119, v51, v189, v23
    v_mfma_f32_16x16x32_bf16 a[40:43], a[112:115], v[104:107], a[40:43]
    v_mov_b32_dpp v49, v182 row_ror:8 row_mask:0xf bank_mask:0xf
    v_perm_b32 v120, v48, v178, v23
    v_mfma_f32_16x16x32_bf16 a[44:47], a[112:115], v[108:111], a[44:47]
    s_lshl_b32 s52, s50, 12
    s_add_u32 s52, s52, s57
    v_mfma_f32_16x16x32_bf16 a[48:51], a[116:119], v[96:99], a[48:51]
    ds_read_b128 a[112:115], v28
    v_mad_u32_u24 v29, v149, s59, v6
    v_mfma_f32_16x16x32_bf16 a[52:55], a[116:119], v[100:103], a[52:55]
    v_mov_b32_dpp v50, v186 row_ror:8 row_mask:0xf bank_mask:0xf
    v_perm_b32 v121, v49, v182, v23
    v_mfma_f32_16x16x32_bf16 a[56:59], a[116:119], v[104:107], a[56:59]
    v_mov_b32_dpp v51, v190 row_ror:8 row_mask:0xf bank_mask:0xf
    v_perm_b32 v122, v50, v186, v23
    v_mfma_f32_16x16x32_bf16 a[60:63], a[116:119], v[108:111], a[60:63]
    v_mfma_f32_16x16x32_bf16 a[64:67], a[120:123], v[96:99], a[64:67]
    ds_read_b128 a[116:119], v29
    v_mad_u32_u24 v30, v153, s59, v6
    v_mfma_f32_16x16x32_bf16 a[68:71], a[120:123], v[100:103], a[68:71]
    v_mov_b32_dpp v48, v179 row_ror:8 row_mask:0xf bank_mask:0xf
    v_perm_b32 v123, v51, v190, v23
    v_mfma_f32_16x16x32_bf16 a[72:75], a[120:123], v[104:107], a[72:75]
    v_mov_b32_dpp v49, v183 row_ror:8 row_mask:0xf bank_mask:0xf
    v_perm_b32 v124, v48, v179, v23
    v_mfma_f32_16x16x32_bf16 a[76:79], a[120:123], v[108:111], a[76:79]
    buffer_load_dword v254, v241, s[4:7], s52 offen
    v_mfma_f32_16x16x32_bf16 a[80:83], a[124:127], v[96:99], a[80:83]
    ds_read_b128 a[120:123], v30
    v_mad_u32_u24 v31, v157, s59, v6
    v_mfma_f32_16x16x32_bf16 a[84:87], a[124:127], v[100:103], a[84:87]
    v_mov_b32_dpp v50, v187 row_ror:8 row_mask:0xf bank_mask:0xf
    v_perm_b32 v125, v49, v183, v23
    v_mfma_f32_16x16x32_bf16 a[88:91], a[124:127], v[104:107], a[88:91]
    v_mov_b32_dpp v51, v191 row_ror:8 row_mask:0xf bank_mask:0xf
    v_perm_b32 v126, v50, v187, v23
    v_mfma_f32_16x16x32_bf16 a[92:95], a[124:127], v[108:111], a[92:95]
    v_perm_b32 v127, v51, v191, v23
    s_waitcnt vmcnt(10) lgkmcnt(3)
    v_mfma_f32_16x16x32_bf16 v[64:67], a[96:99], v[112:115], v[64:67]
    ds_read_b128 a[124:127], v31
    v_mad_u32_u24 v24, v130, s59, v6
    v_mfma_f32_16x16x32_bf16 v[68:71], a[96:99], v[116:119], v[68:71]
    v_mov_b32_dpp v48, v192 row_ror:8 row_mask:0xf bank_mask:0xf
    s_add_u32 s58, s56, 8519680
    v_mfma_f32_16x16x32_bf16 v[72:75], a[96:99], v[120:123], v[72:75]
    v_mov_b32_dpp v49, v196 row_ror:8 row_mask:0xf bank_mask:0xf
    v_perm_b32 v96, v48, v192, v23
    v_mfma_f32_16x16x32_bf16 v[76:79], a[96:99], v[124:127], v[76:79]
    buffer_load_dwordx4 v[176:179], v4, s[4:7], s58 offen offset:0
    v_mfma_f32_16x16x32_bf16 v[80:83], a[100:103], v[112:115], v[80:83]
    ds_read_b128 a[96:99], v24
    v_mad_u32_u24 v25, v134, s59, v6
    v_mfma_f32_16x16x32_bf16 v[84:87], a[100:103], v[116:119], v[84:87]
    v_mov_b32_dpp v50, v200 row_ror:8 row_mask:0xf bank_mask:0xf
    v_perm_b32 v97, v49, v196, v23
    v_mfma_f32_16x16x32_bf16 v[88:91], a[100:103], v[120:123], v[88:91]
    v_mov_b32_dpp v51, v204 row_ror:8 row_mask:0xf bank_mask:0xf
    v_perm_b32 v98, v50, v200, v23
    v_mfma_f32_16x16x32_bf16 v[92:95], a[100:103], v[124:127], v[92:95]
    buffer_load_dwordx4 v[180:183], v4, s[4:7], s58 offen offset:2048
    v_mfma_f32_16x16x32_bf16 a[0:3], a[104:107], v[112:115], a[0:3]
    ds_read_b128 a[100:103], v25
    v_mad_u32_u24 v26, v138, s59, v6
    v_mfma_f32_16x16x32_bf16 a[4:7], a[104:107], v[116:119], a[4:7]
    v_mov_b32_dpp v48, v193 row_ror:8 row_mask:0xf bank_mask:0xf
    v_perm_b32 v99, v51, v204, v23
    v_mfma_f32_16x16x32_bf16 a[8:11], a[104:107], v[120:123], a[8:11]
    v_mov_b32_dpp v49, v197 row_ror:8 row_mask:0xf bank_mask:0xf
    v_perm_b32 v100, v48, v193, v23
    v_mfma_f32_16x16x32_bf16 a[12:15], a[104:107], v[124:127], a[12:15]
    buffer_load_dwordx4 v[184:187], v5, s[4:7], s58 offen offset:0
    v_mfma_f32_16x16x32_bf16 a[16:19], a[108:111], v[112:115], a[16:19]
    ds_read_b128 a[104:107], v26
    v_mad_u32_u24 v27, v142, s59, v6
    v_mfma_f32_16x16x32_bf16 a[20:23], a[108:111], v[116:119], a[20:23]
    v_mov_b32_dpp v50, v201 row_ror:8 row_mask:0xf bank_mask:0xf
    v_perm_b32 v101, v49, v197, v23
    v_mfma_f32_16x16x32_bf16 a[24:27], a[108:111], v[120:123], a[24:27]
    v_mov_b32_dpp v51, v205 row_ror:8 row_mask:0xf bank_mask:0xf
    v_perm_b32 v102, v50, v201, v23
    v_mfma_f32_16x16x32_bf16 a[28:31], a[108:111], v[124:127], a[28:31]
    buffer_load_dwordx4 v[188:191], v5, s[4:7], s58 offen offset:2048
    s_waitcnt lgkmcnt(3)
    v_mfma_f32_16x16x32_bf16 a[32:35], a[112:115], v[112:115], a[32:35]
    ds_read_b128 a[108:111], v27
    v_mad_u32_u24 v28, v146, s59, v6
    v_mfma_f32_16x16x32_bf16 a[36:39], a[112:115], v[116:119], a[36:39]
    v_mov_b32_dpp v48, v194 row_ror:8 row_mask:0xf bank_mask:0xf
    v_perm_b32 v103, v51, v205, v23
    v_mfma_f32_16x16x32_bf16 a[40:43], a[112:115], v[120:123], a[40:43]
    v_mov_b32_dpp v49, v198 row_ror:8 row_mask:0xf bank_mask:0xf
    v_perm_b32 v104, v48, v194, v23
    v_mfma_f32_16x16x32_bf16 a[44:47], a[112:115], v[124:127], a[44:47]
    global_load_ushort v14, v60, s[36:37]
    v_mfma_f32_16x16x32_bf16 a[48:51], a[116:119], v[112:115], a[48:51]
    ds_read_b128 a[112:115], v28
    v_mad_u32_u24 v29, v150, s59, v6
    v_mfma_f32_16x16x32_bf16 a[52:55], a[116:119], v[116:119], a[52:55]
    v_mov_b32_dpp v50, v202 row_ror:8 row_mask:0xf bank_mask:0xf
    v_perm_b32 v105, v49, v198, v23
    v_mfma_f32_16x16x32_bf16 a[56:59], a[116:119], v[120:123], a[56:59]
    v_mov_b32_dpp v51, v206 row_ror:8 row_mask:0xf bank_mask:0xf
    v_perm_b32 v106, v50, v202, v23
    v_mfma_f32_16x16x32_bf16 a[60:63], a[116:119], v[124:127], a[60:63]
    global_load_ushort v15, v60, s[36:37] offset:128
    v_mfma_f32_16x16x32_bf16 a[64:67], a[120:123], v[112:115], a[64:67]
    ds_read_b128 a[116:119], v29
    v_mad_u32_u24 v30, v154, s59, v6
    v_mfma_f32_16x16x32_bf16 a[68:71], a[120:123], v[116:119], a[68:71]
    v_mov_b32_dpp v48, v195 row_ror:8 row_mask:0xf bank_mask:0xf
    v_perm_b32 v107, v51, v206, v23
    v_mfma_f32_16x16x32_bf16 a[72:75], a[120:123], v[120:123], a[72:75]
    v_mov_b32_dpp v49, v199 row_ror:8 row_mask:0xf bank_mask:0xf
    v_perm_b32 v108, v48, v195, v23
    v_mfma_f32_16x16x32_bf16 a[76:79], a[120:123], v[124:127], a[76:79]
    global_load_ushort v16, v60, s[38:39]
    v_mfma_f32_16x16x32_bf16 a[80:83], a[124:127], v[112:115], a[80:83]
    ds_read_b128 a[120:123], v30
    v_mad_u32_u24 v31, v158, s59, v6
    v_mfma_f32_16x16x32_bf16 a[84:87], a[124:127], v[116:119], a[84:87]
    v_mov_b32_dpp v50, v203 row_ror:8 row_mask:0xf bank_mask:0xf
    v_perm_b32 v109, v49, v199, v23
    v_mfma_f32_16x16x32_bf16 a[88:91], a[124:127], v[120:123], a[88:91]
    v_mov_b32_dpp v51, v207 row_ror:8 row_mask:0xf bank_mask:0xf
    v_perm_b32 v110, v50, v203, v23
    v_mfma_f32_16x16x32_bf16 a[92:95], a[124:127], v[124:127], a[92:95]
    v_perm_b32 v111, v51, v207, v23
    s_waitcnt vmcnt(13) lgkmcnt(3)
    v_mfma_f32_16x16x32_bf16 v[64:67], a[96:99], v[96:99], v[64:67]
    ds_read_b128 a[124:127], v31
    v_mad_u32_u24 v24, v131, s59, v6
    s_add_u32 s58, s56, 8650752
    v_mfma_f32_16x16x32_bf16 v[68:71], a[96:99], v[100:103], v[68:71]
    buffer_load_dwordx4 v[192:195], v4, s[4:7], s58 offen offset:0
    v_mov_b32_dpp v48, v208 row_ror:8 row_mask:0xf bank_mask:0xf
    v_mfma_f32_16x16x32_bf16 v[72:75], a[96:99], v[104:107], v[72:75]
    v_mov_b32_dpp v49, v212 row_ror:8 row_mask:0xf bank_mask:0xf
    v_perm_b32 v112, v48, v208, v23
    s_waitcnt vmcnt(13)
    s_barrier
    v_mfma_f32_16x16x32_bf16 v[76:79], a[96:99], v[108:111], v[76:79]
    ds_read_b128 v[128:131], v32 offset:8192
    v_mfma_f32_16x16x32_bf16 v[80:83], a[100:103], v[96:99], v[80:83]
    ds_read_b128 a[96:99], v24
    v_mad_u32_u24 v25, v135, s59, v6
    v_mfma_f32_16x16x32_bf16 v[84:87], a[100:103], v[100:103], v[84:87]
    v_mov_b32_dpp v50, v216 row_ror:8 row_mask:0xf bank_mask:0xf
    v_perm_b32 v113, v49, v212, v23
    v_mfma_f32_16x16x32_bf16 v[88:91], a[100:103], v[104:107], v[88:91]
    v_mov_b32_dpp v51, v220 row_ror:8 row_mask:0xf bank_mask:0xf
    v_perm_b32 v114, v50, v216, v23
    v_mfma_f32_16x16x32_bf16 v[92:95], a[100:103], v[108:111], v[92:95]
    ds_read_b128 v[132:135], v33 offset:8192
    v_mfma_f32_16x16x32_bf16 a[0:3], a[104:107], v[96:99], a[0:3]
    ds_read_b128 a[100:103], v25
    v_mad_u32_u24 v26, v139, s59, v6
    v_mfma_f32_16x16x32_bf16 a[4:7], a[104:107], v[100:103], a[4:7]
    buffer_load_dwordx4 v[196:199], v4, s[4:7], s58 offen offset:2048
    v_mov_b32_dpp v48, v209 row_ror:8 row_mask:0xf bank_mask:0xf
    v_perm_b32 v115, v51, v220, v23
    v_mfma_f32_16x16x32_bf16 a[8:11], a[104:107], v[104:107], a[8:11]
    v_mov_b32_dpp v49, v213 row_ror:8 row_mask:0xf bank_mask:0xf
    v_perm_b32 v116, v48, v209, v23
    v_mfma_f32_16x16x32_bf16 a[12:15], a[104:107], v[108:111], a[12:15]
    ds_read_b128 v[136:139], v34 offset:8192
    v_mfma_f32_16x16x32_bf16 a[16:19], a[108:111], v[96:99], a[16:19]
    ds_read_b128 a[104:107], v26
    v_mad_u32_u24 v27, v143, s59, v6
    v_mfma_f32_16x16x32_bf16 a[20:23], a[108:111], v[100:103], a[20:23]
    v_mov_b32_dpp v50, v217 row_ror:8 row_mask:0xf bank_mask:0xf
    v_perm_b32 v117, v49, v213, v23
    v_mfma_f32_16x16x32_bf16 a[24:27], a[108:111], v[104:107], a[24:27]
    v_mov_b32_dpp v51, v221 row_ror:8 row_mask:0xf bank_mask:0xf
    v_perm_b32 v118, v50, v217, v23
    v_mfma_f32_16x16x32_bf16 a[28:31], a[108:111], v[108:111], a[28:31]
    ds_read_b128 v[140:143], v35 offset:8192
    s_waitcnt lgkmcnt(7)
    v_mfma_f32_16x16x32_bf16 a[32:35], a[112:115], v[96:99], a[32:35]
    ds_read_b128 a[108:111], v27
    v_mad_u32_u24 v28, v147, s59, v6
    v_mfma_f32_16x16x32_bf16 a[36:39], a[112:115], v[100:103], a[36:39]
    buffer_load_dwordx4 v[200:203], v5, s[4:7], s58 offen offset:0
    v_mov_b32_dpp v48, v210 row_ror:8 row_mask:0xf bank_mask:0xf
    v_perm_b32 v119, v51, v221, v23
    v_mfma_f32_16x16x32_bf16 a[40:43], a[112:115], v[104:107], a[40:43]
    v_mov_b32_dpp v49, v214 row_ror:8 row_mask:0xf bank_mask:0xf
    v_perm_b32 v120, v48, v210, v23
    v_mfma_f32_16x16x32_bf16 a[44:47], a[112:115], v[108:111], a[44:47]
    ds_read_b128 v[144:147], v36 offset:8192
    v_mfma_f32_16x16x32_bf16 a[48:51], a[116:119], v[96:99], a[48:51]
    ds_read_b128 a[112:115], v28
    v_mad_u32_u24 v29, v151, s59, v6
    v_mfma_f32_16x16x32_bf16 a[52:55], a[116:119], v[100:103], a[52:55]
    v_mov_b32_dpp v50, v218 row_ror:8 row_mask:0xf bank_mask:0xf
    v_perm_b32 v121, v49, v214, v23
    v_mfma_f32_16x16x32_bf16 a[56:59], a[116:119], v[104:107], a[56:59]
    v_mov_b32_dpp v51, v222 row_ror:8 row_mask:0xf bank_mask:0xf
    v_perm_b32 v122, v50, v218, v23
    v_mfma_f32_16x16x32_bf16 a[60:63], a[116:119], v[108:111], a[60:63]
    ds_read_b128 v[148:151], v37 offset:8192
    v_mfma_f32_16x16x32_bf16 a[64:67], a[120:123], v[96:99], a[64:67]
    ds_read_b128 a[116:119], v29
    v_mad_u32_u24 v30, v155, s59, v6
    v_mfma_f32_16x16x32_bf16 a[68:71], a[120:123], v[100:103], a[68:71]
    buffer_load_dwordx4 v[204:207], v5, s[4:7], s58 offen offset:2048
    v_mov_b32_dpp v48, v211 row_ror:8 row_mask:0xf bank_mask:0xf
    v_perm_b32 v123, v51, v222, v23
    v_mfma_f32_16x16x32_bf16 a[72:75], a[120:123], v[104:107], a[72:75]
    v_mov_b32_dpp v49, v215 row_ror:8 row_mask:0xf bank_mask:0xf
    v_perm_b32 v124, v48, v211, v23
    v_mfma_f32_16x16x32_bf16 a[76:79], a[120:123], v[108:111], a[76:79]
    ds_read_b128 v[152:155], v38 offset:8192
    v_mfma_f32_16x16x32_bf16 a[80:83], a[124:127], v[96:99], a[80:83]
    ds_read_b128 a[120:123], v30
    v_mad_u32_u24 v31, v159, s59, v6
    v_mfma_f32_16x16x32_bf16 a[84:87], a[124:127], v[100:103], a[84:87]
    v_mov_b32_dpp v50, v219 row_ror:8 row_mask:0xf bank_mask:0xf
    v_perm_b32 v125, v49, v215, v23
    v_mfma_f32_16x16x32_bf16 a[88:91], a[124:127], v[104:107], a[88:91]
    v_mov_b32_dpp v51, v223 row_ror:8 row_mask:0xf bank_mask:0xf
    v_perm_b32 v126, v50, v219, v23
    v_mfma_f32_16x16x32_bf16 a[92:95], a[124:127], v[108:111], a[92:95]
    ds_read_b128 v[156:159], v39 offset:8192
    v_perm_b32 v127, v51, v223, v23
    s_waitcnt vmcnt(12) lgkmcnt(7)
    v_mfma_f32_16x16x32_bf16 v[64:67], a[96:99], v[112:115], v[64:67]
    ds_read_b128 a[124:127], v31
    v_mad_u32_u24 v24, v128, s59, v6
    v_mfma_f32_16x16x32_bf16 v[68:71], a[96:99], v[116:119], v[68:71]
    v_mov_b32_dpp v48, v160 row_ror:8 row_mask:0xf bank_mask:0xf
    s_add_u32 s58, s56, 8781824
    v_mfma_f32_16x16x32_bf16 v[72:75], a[96:99], v[120:123], v[72:75]
    v_mov_b32_dpp v49, v164 row_ror:8 row_mask:0xf bank_mask:0xf
    v_perm_b32 v96, v48, v160, v23
    v_mfma_f32_16x16x32_bf16 v[76:79], a[96:99], v[124:127], v[76:79]
    buffer_load_dwordx4 v[208:211], v4, s[4:7], s58 offen offset:0
    v_mfma_f32_16x16x32_bf16 v[80:83], a[100:103], v[112:115], v[80:83]
    ds_read_b128 a[96:99], v24
    v_mad_u32_u24 v25, v132, s59, v6
    v_mfma_f32_16x16x32_bf16 v[84:87], a[100:103], v[116:119], v[84:87]
    v_mov_b32_dpp v50, v168 row_ror:8 row_mask:0xf bank_mask:0xf
    v_perm_b32 v97, v49, v164, v23
    v_mfma_f32_16x16x32_bf16 v[88:91], a[100:103], v[120:123], v[88:91]
    v_mov_b32_dpp v51, v172 row_ror:8 row_mask:0xf bank_mask:0xf
    v_perm_b32 v98, v50, v168, v23
    v_mfma_f32_16x16x32_bf16 v[92:95], a[100:103], v[124:127], v[92:95]
    buffer_load_dwordx4 v[212:215], v4, s[4:7], s58 offen offset:2048
    v_mfma_f32_16x16x32_bf16 a[0:3], a[104:107], v[112:115], a[0:3]
    ds_read_b128 a[100:103], v25
    v_mad_u32_u24 v26, v136, s59, v6
    v_mfma_f32_16x16x32_bf16 a[4:7], a[104:107], v[116:119], a[4:7]
    v_mov_b32_dpp v48, v161 row_ror:8 row_mask:0xf bank_mask:0xf
    v_perm_b32 v99, v51, v172, v23
    v_mfma_f32_16x16x32_bf16 a[8:11], a[104:107], v[120:123], a[8:11]
    v_mov_b32_dpp v49, v165 row_ror:8 row_mask:0xf bank_mask:0xf
    v_perm_b32 v100, v48, v161, v23
    v_mfma_f32_16x16x32_bf16 a[12:15], a[104:107], v[124:127], a[12:15]
    buffer_load_dwordx4 v[216:219], v5, s[4:7], s58 offen offset:0
    v_mfma_f32_16x16x32_bf16 a[16:19], a[108:111], v[112:115], a[16:19]
    ds_read_b128 a[104:107], v26
    v_mad_u32_u24 v27, v140, s59, v6
    v_mfma_f32_16x16x32_bf16 a[20:23], a[108:111], v[116:119], a[20:23]
    v_mov_b32_dpp v50, v169 row_ror:8 row_mask:0xf bank_mask:0xf
    v_perm_b32 v101, v49, v165, v23
    v_mfma_f32_16x16x32_bf16 a[24:27], a[108:111], v[120:123], a[24:27]
    v_mov_b32_dpp v51, v173 row_ror:8 row_mask:0xf bank_mask:0xf
    v_perm_b32 v102, v50, v169, v23
    v_mfma_f32_16x16x32_bf16 a[28:31], a[108:111], v[124:127], a[28:31]
    buffer_load_dwordx4 v[220:223], v5, s[4:7], s58 offen offset:2048
    s_waitcnt lgkmcnt(3)
    v_mfma_f32_16x16x32_bf16 a[32:35], a[112:115], v[112:115], a[32:35]
    ds_read_b128 a[108:111], v27
    v_mad_u32_u24 v28, v144, s59, v6
    v_mfma_f32_16x16x32_bf16 a[36:39], a[112:115], v[116:119], a[36:39]
    v_mov_b32_dpp v48, v162 row_ror:8 row_mask:0xf bank_mask:0xf
    v_perm_b32 v103, v51, v173, v23
    v_mfma_f32_16x16x32_bf16 a[40:43], a[112:115], v[120:123], a[40:43]
    v_mov_b32_dpp v49, v166 row_ror:8 row_mask:0xf bank_mask:0xf
    v_perm_b32 v104, v48, v162, v23
    v_mfma_f32_16x16x32_bf16 a[44:47], a[112:115], v[124:127], a[44:47]
    global_load_ushort v17, v60, s[38:39] offset:128
    v_mfma_f32_16x16x32_bf16 a[48:51], a[116:119], v[112:115], a[48:51]
    ds_read_b128 a[112:115], v28
    v_mad_u32_u24 v29, v148, s59, v6
    v_mfma_f32_16x16x32_bf16 a[52:55], a[116:119], v[116:119], a[52:55]
    v_mov_b32_dpp v50, v170 row_ror:8 row_mask:0xf bank_mask:0xf
    v_perm_b32 v105, v49, v166, v23
    v_mfma_f32_16x16x32_bf16 a[56:59], a[116:119], v[120:123], a[56:59]
    v_mov_b32_dpp v51, v174 row_ror:8 row_mask:0xf bank_mask:0xf
    v_perm_b32 v106, v50, v170, v23
    v_mfma_f32_16x16x32_bf16 a[60:63], a[116:119], v[124:127], a[60:63]
    global_load_ushort v18, v61, s[28:29]
    v_mfma_f32_16x16x32_bf16 a[64:67], a[120:123], v[112:115], a[64:67]
    ds_read_b128 a[116:119], v29
    v_mad_u32_u24 v30, v152, s59, v6
    v_mfma_f32_16x16x32_bf16 a[68:71], a[120:123], v[116:119], a[68:71]
    v_mov_b32_dpp v48, v163 row_ror:8 row_mask:0xf bank_mask:0xf
    v_perm_b32 v107, v51, v174, v23
    v_mfma_f32_16x16x32_bf16 a[72:75], a[120:123], v[120:123], a[72:75]
    v_mov_b32_dpp v49, v167 row_ror:8 row_mask:0xf bank_mask:0xf
    v_perm_b32 v108, v48, v163, v23
    v_mfma_f32_16x16x32_bf16 a[76:79], a[120:123], v[124:127], a[76:79]
    global_load_ushort v19, v63, s[30:31]
    v_mfma_f32_16x16x32_bf16 a[80:83], a[124:127], v[112:115], a[80:83]
    ds_read_b128 a[120:123], v30
    v_mad_u32_u24 v31, v156, s59, v6
    v_mfma_f32_16x16x32_bf16 a[84:87], a[124:127], v[116:119], a[84:87]
    v_mov_b32_dpp v50, v171 row_ror:8 row_mask:0xf bank_mask:0xf
    v_perm_b32 v109, v49, v167, v23
    v_mfma_f32_16x16x32_bf16 a[88:91], a[124:127], v[120:123], a[88:91]
    v_mov_b32_dpp v51, v175 row_ror:8 row_mask:0xf bank_mask:0xf
    v_perm_b32 v110, v50, v171, v23
    v_mfma_f32_16x16x32_bf16 a[92:95], a[124:127], v[124:127], a[92:95]
    v_perm_b32 v111, v51, v175, v23
    s_waitcnt vmcnt(14) lgkmcnt(3)
    v_mfma_f32_16x16x32_bf16 v[64:67], a[96:99], v[96:99], v[64:67]
    ds_read_b128 a[124:127], v31
    v_mad_u32_u24 v24, v129, s59, v6
    v_mfma_f32_16x16x32_bf16 v[68:71], a[96:99], v[100:103], v[68:71]
    v_mov_b32_dpp v48, v176 row_ror:8 row_mask:0xf bank_mask:0xf
    s_add_u32 s58, s56, 10485760
    v_mfma_f32_16x16x32_bf16 v[72:75], a[96:99], v[104:107], v[72:75]
    v_mov_b32_dpp v49, v180 row_ror:8 row_mask:0xf bank_mask:0xf
    v_perm_b32 v112, v48, v176, v23
    v_mfma_f32_16x16x32_bf16 v[76:79], a[96:99], v[108:111], v[76:79]
    buffer_load_dwordx4 v[160:163], v4, s[4:7], s58 offen offset:0
    v_mfma_f32_16x16x32_bf16 v[80:83], a[100:103], v[96:99], v[80:83]
    ds_read_b128 a[96:99], v24
    v_mad_u32_u24 v25, v133, s59, v6
    v_mfma_f32_16x16x32_bf16 v[84:87], a[100:103], v[100:103], v[84:87]
    v_mov_b32_dpp v50, v184 row_ror:8 row_mask:0xf bank_mask:0xf
    v_perm_b32 v113, v49, v180, v23
    v_mfma_f32_16x16x32_bf16 v[88:91], a[100:103], v[104:107], v[88:91]
    v_mov_b32_dpp v51, v188 row_ror:8 row_mask:0xf bank_mask:0xf
    v_perm_b32 v114, v50, v184, v23
    v_mfma_f32_16x16x32_bf16 v[92:95], a[100:103], v[108:111], v[92:95]
    buffer_load_dwordx4 v[164:167], v4, s[4:7], s58 offen offset:2048
    v_mfma_f32_16x16x32_bf16 a[0:3], a[104:107], v[96:99], a[0:3]
    ds_read_b128 a[100:103], v25
    v_mad_u32_u24 v26, v137, s59, v6
    v_mfma_f32_16x16x32_bf16 a[4:7], a[104:107], v[100:103], a[4:7]
    v_mov_b32_dpp v48, v177 row_ror:8 row_mask:0xf bank_mask:0xf
    v_perm_b32 v115, v51, v188, v23
    v_mfma_f32_16x16x32_bf16 a[8:11], a[104:107], v[104:107], a[8:11]
    v_mov_b32_dpp v49, v181 row_ror:8 row_mask:0xf bank_mask:0xf
    v_perm_b32 v116, v48, v177, v23
    v_mfma_f32_16x16x32_bf16 a[12:15], a[104:107], v[108:111], a[12:15]
    buffer_load_dwordx4 v[168:171], v5, s[4:7], s58 offen offset:0
    v_mfma_f32_16x16x32_bf16 a[16:19], a[108:111], v[96:99], a[16:19]
    ds_read_b128 a[104:107], v26
    v_mad_u32_u24 v27, v141, s59, v6
    v_mfma_f32_16x16x32_bf16 a[20:23], a[108:111], v[100:103], a[20:23]
    v_mov_b32_dpp v50, v185 row_ror:8 row_mask:0xf bank_mask:0xf
    v_perm_b32 v117, v49, v181, v23
    v_mfma_f32_16x16x32_bf16 a[24:27], a[108:111], v[104:107], a[24:27]
    v_mov_b32_dpp v51, v189 row_ror:8 row_mask:0xf bank_mask:0xf
    v_perm_b32 v118, v50, v185, v23
    v_mfma_f32_16x16x32_bf16 a[28:31], a[108:111], v[108:111], a[28:31]
    buffer_load_dwordx4 v[172:175], v5, s[4:7], s58 offen offset:2048
    s_waitcnt lgkmcnt(3)
    v_mfma_f32_16x16x32_bf16 a[32:35], a[112:115], v[96:99], a[32:35]
    ds_read_b128 a[108:111], v27
    v_mad_u32_u24 v28, v145, s59, v6
    v_mfma_f32_16x16x32_bf16 a[36:39], a[112:115], v[100:103], a[36:39]
    v_mov_b32_dpp v48, v178 row_ror:8 row_mask:0xf bank_mask:0xf
    v_perm_b32 v119, v51, v189, v23
    v_mfma_f32_16x16x32_bf16 a[40:43], a[112:115], v[104:107], a[40:43]
    v_mov_b32_dpp v49, v182 row_ror:8 row_mask:0xf bank_mask:0xf
    v_perm_b32 v120, v48, v178, v23
    v_mfma_f32_16x16x32_bf16 a[44:47], a[112:115], v[108:111], a[44:47]
    global_load_ushort v20, v62, s[32:33]
    v_mfma_f32_16x16x32_bf16 a[48:51], a[116:119], v[96:99], a[48:51]
    ds_read_b128 a[112:115], v28
    v_mad_u32_u24 v29, v149, s59, v6
    v_mfma_f32_16x16x32_bf16 a[52:55], a[116:119], v[100:103], a[52:55]
    v_mov_b32_dpp v50, v186 row_ror:8 row_mask:0xf bank_mask:0xf
    v_perm_b32 v121, v49, v182, v23
    v_mfma_f32_16x16x32_bf16 a[56:59], a[116:119], v[104:107], a[56:59]
    v_mov_b32_dpp v51, v190 row_ror:8 row_mask:0xf bank_mask:0xf
    v_perm_b32 v122, v50, v186, v23
    v_mfma_f32_16x16x32_bf16 a[60:63], a[116:119], v[108:111], a[60:63]
    global_load_ushort v21, v62, s[40:41]
    v_mfma_f32_16x16x32_bf16 a[64:67], a[120:123], v[96:99], a[64:67]
    ds_read_b128 a[116:119], v29
    v_mad_u32_u24 v30, v153, s59, v6
    v_mfma_f32_16x16x32_bf16 a[68:71], a[120:123], v[100:103], a[68:71]
    v_mov_b32_dpp v48, v179 row_ror:8 row_mask:0xf bank_mask:0xf
    v_perm_b32 v123, v51, v190, v23
    v_mfma_f32_16x16x32_bf16 a[72:75], a[120:123], v[104:107], a[72:75]
    v_mov_b32_dpp v49, v183 row_ror:8 row_mask:0xf bank_mask:0xf
    v_perm_b32 v124, v48, v179, v23
    v_mfma_f32_16x16x32_bf16 a[76:79], a[120:123], v[108:111], a[76:79]
    buffer_load_dword v22, v62, s[20:23], 0 offen sc1
    v_mfma_f32_16x16x32_bf16 a[80:83], a[124:127], v[96:99], a[80:83]
    ds_read_b128 a[120:123], v30
    v_mad_u32_u24 v31, v157, s59, v6
    v_mfma_f32_16x16x32_bf16 a[84:87], a[124:127], v[100:103], a[84:87]
    v_mov_b32_dpp v50, v187 row_ror:8 row_mask:0xf bank_mask:0xf
    v_perm_b32 v125, v49, v183, v23
    v_mfma_f32_16x16x32_bf16 a[88:91], a[124:127], v[104:107], a[88:91]
    v_mov_b32_dpp v51, v191 row_ror:8 row_mask:0xf bank_mask:0xf
    v_perm_b32 v126, v50, v187, v23
    v_mfma_f32_16x16x32_bf16 a[92:95], a[124:127], v[108:111], a[92:95]
    v_perm_b32 v127, v51, v191, v23
    s_waitcnt vmcnt(14) lgkmcnt(3)
    v_mfma_f32_16x16x32_bf16 v[64:67], a[96:99], v[112:115], v[64:67]
    ds_read_b128 a[124:127], v31
    v_mad_u32_u24 v24, v130, s59, v6
    v_mfma_f32_16x16x32_bf16 v[68:71], a[96:99], v[116:119], v[68:71]
    v_mov_b32_dpp v48, v192 row_ror:8 row_mask:0xf bank_mask:0xf
    s_add_u32 s58, s56, 10616832
    v_mfma_f32_16x16x32_bf16 v[72:75], a[96:99], v[120:123], v[72:75]
    v_mov_b32_dpp v49, v196 row_ror:8 row_mask:0xf bank_mask:0xf
    v_perm_b32 v96, v48, v192, v23
    v_mfma_f32_16x16x32_bf16 v[76:79], a[96:99], v[124:127], v[76:79]
    buffer_load_dwordx4 v[176:179], v4, s[4:7], s58 offen offset:0
    v_mfma_f32_16x16x32_bf16 v[80:83], a[100:103], v[112:115], v[80:83]
    ds_read_b128 a[96:99], v24
    v_mad_u32_u24 v25, v134, s59, v6
    v_mfma_f32_16x16x32_bf16 v[84:87], a[100:103], v[116:119], v[84:87]
    v_mov_b32_dpp v50, v200 row_ror:8 row_mask:0xf bank_mask:0xf
    v_perm_b32 v97, v49, v196, v23
    v_mfma_f32_16x16x32_bf16 v[88:91], a[100:103], v[120:123], v[88:91]
    v_mov_b32_dpp v51, v204 row_ror:8 row_mask:0xf bank_mask:0xf
    v_perm_b32 v98, v50, v200, v23
    v_mfma_f32_16x16x32_bf16 v[92:95], a[100:103], v[124:127], v[92:95]
    buffer_load_dwordx4 v[180:183], v4, s[4:7], s58 offen offset:2048
    v_mfma_f32_16x16x32_bf16 a[0:3], a[104:107], v[112:115], a[0:3]
    ds_read_b128 a[100:103], v25
    v_mad_u32_u24 v26, v138, s59, v6
    v_mfma_f32_16x16x32_bf16 a[4:7], a[104:107], v[116:119], a[4:7]
    v_mov_b32_dpp v48, v193 row_ror:8 row_mask:0xf bank_mask:0xf
    v_perm_b32 v99, v51, v204, v23
    v_mfma_f32_16x16x32_bf16 a[8:11], a[104:107], v[120:123], a[8:11]
    v_mov_b32_dpp v49, v197 row_ror:8 row_mask:0xf bank_mask:0xf
    v_perm_b32 v100, v48, v193, v23
    v_mfma_f32_16x16x32_bf16 a[12:15], a[104:107], v[124:127], a[12:15]
    buffer_load_dwordx4 v[184:187], v5, s[4:7], s58 offen offset:0
    v_mfma_f32_16x16x32_bf16 a[16:19], a[108:111], v[112:115], a[16:19]
    ds_read_b128 a[104:107], v26
    v_mad_u32_u24 v27, v142, s59, v6
    v_mfma_f32_16x16x32_bf16 a[20:23], a[108:111], v[116:119], a[20:23]
    v_mov_b32_dpp v50, v201 row_ror:8 row_mask:0xf bank_mask:0xf
    v_perm_b32 v101, v49, v197, v23
    v_mfma_f32_16x16x32_bf16 a[24:27], a[108:111], v[120:123], a[24:27]
    v_mov_b32_dpp v51, v205 row_ror:8 row_mask:0xf bank_mask:0xf
    v_perm_b32 v102, v50, v201, v23
    v_mfma_f32_16x16x32_bf16 a[28:31], a[108:111], v[124:127], a[28:31]
    buffer_load_dwordx4 v[188:191], v5, s[4:7], s58 offen offset:2048
    s_waitcnt lgkmcnt(3)
    v_mfma_f32_16x16x32_bf16 a[32:35], a[112:115], v[112:115], a[32:35]
    ds_read_b128 a[108:111], v27
    v_mad_u32_u24 v28, v146, s59, v6
    v_mfma_f32_16x16x32_bf16 a[36:39], a[112:115], v[116:119], a[36:39]
    v_mov_b32_dpp v48, v194 row_ror:8 row_mask:0xf bank_mask:0xf
    v_perm_b32 v103, v51, v205, v23
    v_mfma_f32_16x16x32_bf16 a[40:43], a[112:115], v[120:123], a[40:43]
    v_mov_b32_dpp v49, v198 row_ror:8 row_mask:0xf bank_mask:0xf
    v_perm_b32 v104, v48, v194, v23
    v_mfma_f32_16x16x32_bf16 a[44:47], a[112:115], v[124:127], a[44:47]
    v_mfma_f32_16x16x32_bf16 a[48:51], a[116:119], v[112:115], a[48:51]
    ds_read_b128 a[112:115], v28
    v_mad_u32_u24 v29, v150, s59, v6
    v_mfma_f32_16x16x32_bf16 a[52:55], a[116:119], v[116:119], a[52:55]
    v_mov_b32_dpp v50, v202 row_ror:8 row_mask:0xf bank_mask:0xf
    v_perm_b32 v105, v49, v198, v23
    v_mfma_f32_16x16x32_bf16 a[56:59], a[116:119], v[120:123], a[56:59]
    v_mov_b32_dpp v51, v206 row_ror:8 row_mask:0xf bank_mask:0xf
    v_perm_b32 v106, v50, v202, v23
    v_mfma_f32_16x16x32_bf16 a[60:63], a[116:119], v[124:127], a[60:63]
    v_mfma_f32_16x16x32_bf16 a[64:67], a[120:123], v[112:115], a[64:67]
    ds_read_b128 a[116:119], v29
    v_mad_u32_u24 v30, v154, s59, v6
    v_mfma_f32_16x16x32_bf16 a[68:71], a[120:123], v[116:119], a[68:71]
    v_mov_b32_dpp v48, v195 row_ror:8 row_mask:0xf bank_mask:0xf
    v_perm_b32 v107, v51, v206, v23
    v_mfma_f32_16x16x32_bf16 a[72:75], a[120:123], v[120:123], a[72:75]
    v_mov_b32_dpp v49, v199 row_ror:8 row_mask:0xf bank_mask:0xf
    v_perm_b32 v108, v48, v195, v23
    v_mfma_f32_16x16x32_bf16 a[76:79], a[120:123], v[124:127], a[76:79]
    v_mfma_f32_16x16x32_bf16 a[80:83], a[124:127], v[112:115], a[80:83]
    ds_read_b128 a[120:123], v30
    v_mad_u32_u24 v31, v158, s59, v6
    v_mfma_f32_16x16x32_bf16 a[84:87], a[124:127], v[116:119], a[84:87]
    v_mov_b32_dpp v50, v203 row_ror:8 row_mask:0xf bank_mask:0xf
    v_perm_b32 v109, v49, v199, v23
    v_mfma_f32_16x16x32_bf16 a[88:91], a[124:127], v[120:123], a[88:91]
    v_mov_b32_dpp v51, v207 row_ror:8 row_mask:0xf bank_mask:0xf
    v_perm_b32 v110, v50, v203, v23
    v_mfma_f32_16x16x32_bf16 a[92:95], a[124:127], v[124:127], a[92:95]
    v_perm_b32 v111, v51, v207, v23
    s_waitcnt vmcnt(14) lgkmcnt(3)
    v_mfma_f32_16x16x32_bf16 v[64:67], a[96:99], v[96:99], v[64:67]
    ds_read_b128 a[124:127], v31
    v_mad_u32_u24 v24, v131, s59, v6
    s_add_u32 s58, s56, 10747904
    v_mfma_f32_16x16x32_bf16 v[68:71], a[96:99], v[100:103], v[68:71]
    buffer_load_dwordx4 v[192:195], v4, s[4:7], s58 offen offset:0
    v_mov_b32_dpp v48, v208 row_ror:8 row_mask:0xf bank_mask:0xf
    v_mfma_f32_16x16x32_bf16 v[72:75], a[96:99], v[104:107], v[72:75]
    v_mov_b32_dpp v49, v212 row_ror:8 row_mask:0xf bank_mask:0xf
    v_perm_b32 v112, v48, v208, v23
    v_mfma_f32_16x16x32_bf16 v[76:79], a[96:99], v[108:111], v[76:79]
    ds_read_b128 v[128:131], v32 offset:0
    v_mfma_f32_16x16x32_bf16 v[80:83], a[100:103], v[96:99], v[80:83]
    ds_read_b128 a[96:99], v24
    v_mad_u32_u24 v25, v135, s59, v6
    v_mfma_f32_16x16x32_bf16 v[84:87], a[100:103], v[100:103], v[84:87]
    v_mov_b32_dpp v50, v216 row_ror:8 row_mask:0xf bank_mask:0xf
    v_perm_b32 v113, v49, v212, v23
    v_mfma_f32_16x16x32_bf16 v[88:91], a[100:103], v[104:107], v[88:91]
    v_mov_b32_dpp v51, v220 row_ror:8 row_mask:0xf bank_mask:0xf
    v_perm_b32 v114, v50, v216, v23
    v_mfma_f32_16x16x32_bf16 v[92:95], a[100:103], v[108:111], v[92:95]
    ds_read_b128 v[132:135], v33 offset:0
    v_mfma_f32_16x16x32_bf16 a[0:3], a[104:107], v[96:99], a[0:3]
    ds_read_b128 a[100:103], v25
    v_mad_u32_u24 v26, v139, s59, v6
    v_mfma_f32_16x16x32_bf16 a[4:7], a[104:107], v[100:103], a[4:7]
    buffer_load_dwordx4 v[196:199], v4, s[4:7], s58 offen offset:2048
    v_mov_b32_dpp v48, v209 row_ror:8 row_mask:0xf bank_mask:0xf
    v_perm_b32 v115, v51, v220, v23
    v_mfma_f32_16x16x32_bf16 a[8:11], a[104:107], v[104:107], a[8:11]
    v_mov_b32_dpp v49, v213 row_ror:8 row_mask:0xf bank_mask:0xf
    v_perm_b32 v116, v48, v209, v23
    v_mfma_f32_16x16x32_bf16 a[12:15], a[104:107], v[108:111], a[12:15]
    ds_read_b128 v[136:139], v34 offset:0
    v_mfma_f32_16x16x32_bf16 a[16:19], a[108:111], v[96:99], a[16:19]
    ds_read_b128 a[104:107], v26
    v_mad_u32_u24 v27, v143, s59, v6
    v_mfma_f32_16x16x32_bf16 a[20:23], a[108:111], v[100:103], a[20:23]
    v_mov_b32_dpp v50, v217 row_ror:8 row_mask:0xf bank_mask:0xf
    v_perm_b32 v117, v49, v213, v23
    v_mfma_f32_16x16x32_bf16 a[24:27], a[108:111], v[104:107], a[24:27]
    v_mov_b32_dpp v51, v221 row_ror:8 row_mask:0xf bank_mask:0xf
    v_perm_b32 v118, v50, v217, v23
    v_mfma_f32_16x16x32_bf16 a[28:31], a[108:111], v[108:111], a[28:31]
    ds_read_b128 v[140:143], v35 offset:0
    s_waitcnt lgkmcnt(7)
    v_mfma_f32_16x16x32_bf16 a[32:35], a[112:115], v[96:99], a[32:35]
    ds_read_b128 a[108:111], v27
    v_mad_u32_u24 v28, v147, s59, v6
    v_mfma_f32_16x16x32_bf16 a[36:39], a[112:115], v[100:103], a[36:39]
    buffer_load_dwordx4 v[200:203], v5, s[4:7], s58 offen offset:0
    v_mov_b32_dpp v48, v210 row_ror:8 row_mask:0xf bank_mask:0xf
    v_perm_b32 v119, v51, v221, v23
    v_mfma_f32_16x16x32_bf16 a[40:43], a[112:115], v[104:107], a[40:43]
    v_mov_b32_dpp v49, v214 row_ror:8 row_mask:0xf bank_mask:0xf
    v_perm_b32 v120, v48, v210, v23
    v_mfma_f32_16x16x32_bf16 a[44:47], a[112:115], v[108:111], a[44:47]
    ds_read_b128 v[144:147], v36 offset:0
    v_mfma_f32_16x16x32_bf16 a[48:51], a[116:119], v[96:99], a[48:51]
    ds_read_b128 a[112:115], v28
    v_mad_u32_u24 v29, v151, s59, v6
    v_mfma_f32_16x16x32_bf16 a[52:55], a[116:119], v[100:103], a[52:55]
    v_mov_b32_dpp v50, v218 row_ror:8 row_mask:0xf bank_mask:0xf
    v_perm_b32 v121, v49, v214, v23
    v_mfma_f32_16x16x32_bf16 a[56:59], a[116:119], v[104:107], a[56:59]
    v_mov_b32_dpp v51, v222 row_ror:8 row_mask:0xf bank_mask:0xf
    v_perm_b32 v122, v50, v218, v23
    v_mfma_f32_16x16x32_bf16 a[60:63], a[116:119], v[108:111], a[60:63]
    ds_read_b128 v[148:151], v37 offset:0
    v_mfma_f32_16x16x32_bf16 a[64:67], a[120:123], v[96:99], a[64:67]
    ds_read_b128 a[116:119], v29
    v_mad_u32_u24 v30, v155, s59, v6
    v_mfma_f32_16x16x32_bf16 a[68:71], a[120:123], v[100:103], a[68:71]
    buffer_load_dwordx4 v[204:207], v5, s[4:7], s58 offen offset:2048
    v_mov_b32_dpp v48, v211 row_ror:8 row_mask:0xf bank_mask:0xf
    v_perm_b32 v123, v51, v222, v23
    v_mfma_f32_16x16x32_bf16 a[72:75], a[120:123], v[104:107], a[72:75]
    v_mov_b32_dpp v49, v215 row_ror:8 row_mask:0xf bank_mask:0xf
    v_perm_b32 v124, v48, v211, v23
    v_mfma_f32_16x16x32_bf16 a[76:79], a[120:123], v[108:111], a[76:79]
    ds_read_b128 v[152:155], v38 offset:0
    v_mfma_f32_16x16x32_bf16 a[80:83], a[124:127], v[96:99], a[80:83]
    ds_read_b128 a[120:123], v30
    v_mad_u32_u24 v31, v159, s59, v6
    v_mfma_f32_16x16x32_bf16 a[84:87], a[124:127], v[100:103], a[84:87]
    v_mov_b32_dpp v50, v219 row_ror:8 row_mask:0xf bank_mask:0xf
    v_perm_b32 v125, v49, v215, v23
    v_mfma_f32_16x16x32_bf16 a[88:91], a[124:127], v[104:107], a[88:91]
    v_mov_b32_dpp v51, v223 row_ror:8 row_mask:0xf bank_mask:0xf
    v_perm_b32 v126, v50, v219, v23
    v_mfma_f32_16x16x32_bf16 a[92:95], a[124:127], v[108:111], a[92:95]
    ds_read_b128 v[156:159], v39 offset:0
    v_perm_b32 v127, v51, v223, v23
    s_waitcnt vmcnt(11) lgkmcnt(7)
    v_mfma_f32_16x16x32_bf16 v[64:67], a[96:99], v[112:115], v[64:67]
    ds_read_b128 a[124:127], v31
    v_mad_u32_u24 v24, v128, s59, v6
    v_mfma_f32_16x16x32_bf16 v[68:71], a[96:99], v[116:119], v[68:71]
    v_mov_b32_dpp v48, v160 row_ror:8 row_mask:0xf bank_mask:0xf
    s_add_u32 s58, s56, 10878976
    v_mfma_f32_16x16x32_bf16 v[72:75], a[96:99], v[120:123], v[72:75]
    v_mov_b32_dpp v49, v164 row_ror:8 row_mask:0xf bank_mask:0xf
    v_perm_b32 v96, v48, v160, v23
    v_mfma_f32_16x16x32_bf16 v[76:79], a[96:99], v[124:127], v[76:79]
    buffer_load_dwordx4 v[208:211], v4, s[4:7], s58 offen offset:0
    v_mfma_f32_16x16x32_bf16 v[80:83], a[100:103], v[112:115], v[80:83]
    ds_read_b128 a[96:99], v24
    v_mad_u32_u24 v25, v132, s59, v6
    v_mfma_f32_16x16x32_bf16 v[84:87], a[100:103], v[116:119], v[84:87]
    v_mov_b32_dpp v50, v168 row_ror:8 row_mask:0xf bank_mask:0xf
    v_perm_b32 v97, v49, v164, v23
    v_mfma_f32_16x16x32_bf16 v[88:91], a[100:103], v[120:123], v[88:91]
    v_mov_b32_dpp v51, v172 row_ror:8 row_mask:0xf bank_mask:0xf
    v_perm_b32 v98, v50, v168, v23
    v_mfma_f32_16x16x32_bf16 v[92:95], a[100:103], v[124:127], v[92:95]
    buffer_load_dwordx4 v[212:215], v4, s[4:7], s58 offen offset:2048
    v_mfma_f32_16x16x32_bf16 a[0:3], a[104:107], v[112:115], a[0:3]
    ds_read_b128 a[100:103], v25
    v_mad_u32_u24 v26, v136, s59, v6
    v_mfma_f32_16x16x32_bf16 a[4:7], a[104:107], v[116:119], a[4:7]
    v_mov_b32_dpp v48, v161 row_ror:8 row_mask:0xf bank_mask:0xf
    v_perm_b32 v99, v51, v172, v23
    v_mfma_f32_16x16x32_bf16 a[8:11], a[104:107], v[120:123], a[8:11]
    v_mov_b32_dpp v49, v165 row_ror:8 row_mask:0xf bank_mask:0xf
    v_perm_b32 v100, v48, v161, v23
    v_mfma_f32_16x16x32_bf16 a[12:15], a[104:107], v[124:127], a[12:15]
    buffer_load_dwordx4 v[216:219], v5, s[4:7], s58 offen offset:0
    v_mfma_f32_16x16x32_bf16 a[16:19], a[108:111], v[112:115], a[16:19]
    ds_read_b128 a[104:107], v26
    v_mad_u32_u24 v27, v140, s59, v6
    v_mfma_f32_16x16x32_bf16 a[20:23], a[108:111], v[116:119], a[20:23]
    v_mov_b32_dpp v50, v169 row_ror:8 row_mask:0xf bank_mask:0xf
    v_perm_b32 v101, v49, v165, v23
    v_mfma_f32_16x16x32_bf16 a[24:27], a[108:111], v[120:123], a[24:27]
    v_mov_b32_dpp v51, v173 row_ror:8 row_mask:0xf bank_mask:0xf
    v_perm_b32 v102, v50, v169, v23
    v_mfma_f32_16x16x32_bf16 a[28:31], a[108:111], v[124:127], a[28:31]
    buffer_load_dwordx4 v[220:223], v5, s[4:7], s58 offen offset:2048
    s_waitcnt lgkmcnt(3)
    v_mfma_f32_16x16x32_bf16 a[32:35], a[112:115], v[112:115], a[32:35]
    ds_read_b128 a[108:111], v27
    v_mad_u32_u24 v28, v144, s59, v6
    v_mfma_f32_16x16x32_bf16 a[36:39], a[112:115], v[116:119], a[36:39]
    v_mov_b32_dpp v48, v162 row_ror:8 row_mask:0xf bank_mask:0xf
    v_perm_b32 v103, v51, v173, v23
    v_mfma_f32_16x16x32_bf16 a[40:43], a[112:115], v[120:123], a[40:43]
    v_mov_b32_dpp v49, v166 row_ror:8 row_mask:0xf bank_mask:0xf
    v_perm_b32 v104, v48, v162, v23
    v_mfma_f32_16x16x32_bf16 a[44:47], a[112:115], v[124:127], a[44:47]
    v_mfma_f32_16x16x32_bf16 a[48:51], a[116:119], v[112:115], a[48:51]
    ds_read_b128 a[112:115], v28
    v_mad_u32_u24 v29, v148, s59, v6
    v_mfma_f32_16x16x32_bf16 a[52:55], a[116:119], v[116:119], a[52:55]
    v_mov_b32_dpp v50, v170 row_ror:8 row_mask:0xf bank_mask:0xf
    v_perm_b32 v105, v49, v166, v23
    v_mfma_f32_16x16x32_bf16 a[56:59], a[116:119], v[120:123], a[56:59]
    v_mov_b32_dpp v51, v174 row_ror:8 row_mask:0xf bank_mask:0xf
    v_perm_b32 v106, v50, v170, v23
    v_mfma_f32_16x16x32_bf16 a[60:63], a[116:119], v[124:127], a[60:63]
    v_mfma_f32_16x16x32_bf16 a[64:67], a[120:123], v[112:115], a[64:67]
    ds_read_b128 a[116:119], v29
    v_mad_u32_u24 v30, v152, s59, v6
    v_mfma_f32_16x16x32_bf16 a[68:71], a[120:123], v[116:119], a[68:71]
    v_mov_b32_dpp v48, v163 row_ror:8 row_mask:0xf bank_mask:0xf
    v_perm_b32 v107, v51, v174, v23
    v_mfma_f32_16x16x32_bf16 a[72:75], a[120:123], v[120:123], a[72:75]
    v_mov_b32_dpp v49, v167 row_ror:8 row_mask:0xf bank_mask:0xf
    v_perm_b32 v108, v48, v163, v23
    v_mfma_f32_16x16x32_bf16 a[76:79], a[120:123], v[124:127], a[76:79]
    v_mfma_f32_16x16x32_bf16 a[80:83], a[124:127], v[112:115], a[80:83]
    ds_read_b128 a[120:123], v30
    v_mad_u32_u24 v31, v156, s59, v6
    v_mfma_f32_16x16x32_bf16 a[84:87], a[124:127], v[116:119], a[84:87]
    v_mov_b32_dpp v50, v171 row_ror:8 row_mask:0xf bank_mask:0xf
    v_perm_b32 v109, v49, v167, v23
    v_mfma_f32_16x16x32_bf16 a[88:91], a[124:127], v[120:123], a[88:91]
    v_mov_b32_dpp v51, v175 row_ror:8 row_mask:0xf bank_mask:0xf
    v_perm_b32 v110, v50, v171, v23
    v_mfma_f32_16x16x32_bf16 a[92:95], a[124:127], v[124:127], a[92:95]
    v_perm_b32 v111, v51, v175, v23
    s_waitcnt vmcnt(8) lgkmcnt(3)
    v_mfma_f32_16x16x32_bf16 v[64:67], a[96:99], v[96:99], v[64:67]
    ds_read_b128 a[124:127], v31
    v_mad_u32_u24 v24, v129, s59, v6
    v_mfma_f32_16x16x32_bf16 v[68:71], a[96:99], v[100:103], v[68:71]
    v_mov_b32_dpp v48, v176 row_ror:8 row_mask:0xf bank_mask:0xf
    s_mov_b32 s58, s57
    v_mfma_f32_16x16x32_bf16 v[72:75], a[96:99], v[104:107], v[72:75]
    v_mov_b32_dpp v49, v180 row_ror:8 row_mask:0xf bank_mask:0xf
    v_perm_b32 v112, v48, v176, v23
    v_mfma_f32_16x16x32_bf16 v[76:79], a[96:99], v[108:111], v[76:79]
    buffer_load_dwordx4 v[160:163], v4, s[4:7], s58 offen offset:0
    v_mfma_f32_16x16x32_bf16 v[80:83], a[100:103], v[96:99], v[80:83]
    ds_read_b128 a[96:99], v24
    v_mad_u32_u24 v25, v133, s59, v6
    v_mfma_f32_16x16x32_bf16 v[84:87], a[100:103], v[100:103], v[84:87]
    v_mov_b32_dpp v50, v184 row_ror:8 row_mask:0xf bank_mask:0xf
    v_perm_b32 v113, v49, v180, v23
    v_mfma_f32_16x16x32_bf16 v[88:91], a[100:103], v[104:107], v[88:91]
    v_mov_b32_dpp v51, v188 row_ror:8 row_mask:0xf bank_mask:0xf
    v_perm_b32 v114, v50, v184, v23
    v_mfma_f32_16x16x32_bf16 v[92:95], a[100:103], v[108:111], v[92:95]
    buffer_load_dwordx4 v[164:167], v4, s[4:7], s58 offen offset:2048
    v_mfma_f32_16x16x32_bf16 a[0:3], a[104:107], v[96:99], a[0:3]
    ds_read_b128 a[100:103], v25
    v_mad_u32_u24 v26, v137, s59, v6
    v_mfma_f32_16x16x32_bf16 a[4:7], a[104:107], v[100:103], a[4:7]
    v_mov_b32_dpp v48, v177 row_ror:8 row_mask:0xf bank_mask:0xf
    v_perm_b32 v115, v51, v188, v23
    v_mfma_f32_16x16x32_bf16 a[8:11], a[104:107], v[104:107], a[8:11]
    v_mov_b32_dpp v49, v181 row_ror:8 row_mask:0xf bank_mask:0xf
    v_perm_b32 v116, v48, v177, v23
    v_mfma_f32_16x16x32_bf16 a[12:15], a[104:107], v[108:111], a[12:15]
    buffer_load_dwordx4 v[168:171], v5, s[4:7], s58 offen offset:0
    v_mfma_f32_16x16x32_bf16 a[16:19], a[108:111], v[96:99], a[16:19]
    ds_read_b128 a[104:107], v26
    v_mad_u32_u24 v27, v141, s59, v6
    v_mfma_f32_16x16x32_bf16 a[20:23], a[108:111], v[100:103], a[20:23]
    v_mov_b32_dpp v50, v185 row_ror:8 row_mask:0xf bank_mask:0xf
    v_perm_b32 v117, v49, v181, v23
    v_mfma_f32_16x16x32_bf16 a[24:27], a[108:111], v[104:107], a[24:27]
    v_mov_b32_dpp v51, v189 row_ror:8 row_mask:0xf bank_mask:0xf
    v_perm_b32 v118, v50, v185, v23
    v_mfma_f32_16x16x32_bf16 a[28:31], a[108:111], v[108:111], a[28:31]
    buffer_load_dwordx4 v[172:175], v5, s[4:7], s58 offen offset:2048
    s_waitcnt lgkmcnt(3)
    v_mfma_f32_16x16x32_bf16 a[32:35], a[112:115], v[96:99], a[32:35]
    ds_read_b128 a[108:111], v27
    v_mad_u32_u24 v28, v145, s59, v6
    v_mfma_f32_16x16x32_bf16 a[36:39], a[112:115], v[100:103], a[36:39]
    v_mov_b32_dpp v48, v178 row_ror:8 row_mask:0xf bank_mask:0xf
    v_perm_b32 v119, v51, v189, v23
    v_mfma_f32_16x16x32_bf16 a[40:43], a[112:115], v[104:107], a[40:43]
    v_mov_b32_dpp v49, v182 row_ror:8 row_mask:0xf bank_mask:0xf
    v_perm_b32 v120, v48, v178, v23
    v_mfma_f32_16x16x32_bf16 a[44:47], a[112:115], v[108:111], a[44:47]
    v_mfma_f32_16x16x32_bf16 a[48:51], a[116:119], v[96:99], a[48:51]
    ds_read_b128 a[112:115], v28
    v_mad_u32_u24 v29, v149, s59, v6
    v_mfma_f32_16x16x32_bf16 a[52:55], a[116:119], v[100:103], a[52:55]
    v_mov_b32_dpp v50, v186 row_ror:8 row_mask:0xf bank_mask:0xf
    v_perm_b32 v121, v49, v182, v23
    v_mfma_f32_16x16x32_bf16 a[56:59], a[116:119], v[104:107], a[56:59]
    v_mov_b32_dpp v51, v190 row_ror:8 row_mask:0xf bank_mask:0xf
    v_perm_b32 v122, v50, v186, v23
    v_mfma_f32_16x16x32_bf16 a[60:63], a[116:119], v[108:111], a[60:63]
    v_mfma_f32_16x16x32_bf16 a[64:67], a[120:123], v[96:99], a[64:67]
    ds_read_b128 a[116:119], v29
    v_mad_u32_u24 v30, v153, s59, v6
    v_mfma_f32_16x16x32_bf16 a[68:71], a[120:123], v[100:103], a[68:71]
    v_mov_b32_dpp v48, v179 row_ror:8 row_mask:0xf bank_mask:0xf
    v_perm_b32 v123, v51, v190, v23
    v_mfma_f32_16x16x32_bf16 a[72:75], a[120:123], v[104:107], a[72:75]
    v_mov_b32_dpp v49, v183 row_ror:8 row_mask:0xf bank_mask:0xf
    v_perm_b32 v124, v48, v179, v23
    v_mfma_f32_16x16x32_bf16 a[76:79], a[120:123], v[108:111], a[76:79]
    v_mfma_f32_16x16x32_bf16 a[80:83], a[124:127], v[96:99], a[80:83]
    ds_read_b128 a[120:123], v30
    v_mad_u32_u24 v31, v157, s59, v6
    v_mfma_f32_16x16x32_bf16 a[84:87], a[124:127], v[100:103], a[84:87]
    v_mov_b32_dpp v50, v187 row_ror:8 row_mask:0xf bank_mask:0xf
    v_perm_b32 v125, v49, v183, v23
    v_mfma_f32_16x16x32_bf16 a[88:91], a[124:127], v[104:107], a[88:91]
    v_mov_b32_dpp v51, v191 row_ror:8 row_mask:0xf bank_mask:0xf
    v_perm_b32 v126, v50, v187, v23
    v_mfma_f32_16x16x32_bf16 a[92:95], a[124:127], v[108:111], a[92:95]
    v_perm_b32 v127, v51, v191, v23
    s_waitcnt vmcnt(8) lgkmcnt(3)
    v_mfma_f32_16x16x32_bf16 v[64:67], a[96:99], v[112:115], v[64:67]
    ds_read_b128 a[124:127], v31
    v_mad_u32_u24 v24, v130, s59, v6
    v_mfma_f32_16x16x32_bf16 v[68:71], a[96:99], v[116:119], v[68:71]
    v_mov_b32_dpp v48, v192 row_ror:8 row_mask:0xf bank_mask:0xf
    v_mfma_f32_16x16x32_bf16 v[72:75], a[96:99], v[120:123], v[72:75]
    v_mov_b32_dpp v49, v196 row_ror:8 row_mask:0xf bank_mask:0xf
    v_perm_b32 v96, v48, v192, v23
    v_mfma_f32_16x16x32_bf16 v[76:79], a[96:99], v[124:127], v[76:79]
    v_mfma_f32_16x16x32_bf16 v[80:83], a[100:103], v[112:115], v[80:83]
    ds_read_b128 a[96:99], v24
    v_mad_u32_u24 v25, v134, s59, v6
    v_mfma_f32_16x16x32_bf16 v[84:87], a[100:103], v[116:119], v[84:87]
    v_mov_b32_dpp v50, v200 row_ror:8 row_mask:0xf bank_mask:0xf
    v_perm_b32 v97, v49, v196, v23
    v_mfma_f32_16x16x32_bf16 v[88:91], a[100:103], v[120:123], v[88:91]
    v_mov_b32_dpp v51, v204 row_ror:8 row_mask:0xf bank_mask:0xf
    v_perm_b32 v98, v50, v200, v23
    v_mfma_f32_16x16x32_bf16 v[92:95], a[100:103], v[124:127], v[92:95]
    v_mfma_f32_16x16x32_bf16 a[0:3], a[104:107], v[112:115], a[0:3]
    ds_read_b128 a[100:103], v25
    v_mad_u32_u24 v26, v138, s59, v6
    v_mfma_f32_16x16x32_bf16 a[4:7], a[104:107], v[116:119], a[4:7]
    v_mov_b32_dpp v48, v193 row_ror:8 row_mask:0xf bank_mask:0xf
    v_perm_b32 v99, v51, v204, v23
    v_mfma_f32_16x16x32_bf16 a[8:11], a[104:107], v[120:123], a[8:11]
    v_mov_b32_dpp v49, v197 row_ror:8 row_mask:0xf bank_mask:0xf
    v_perm_b32 v100, v48, v193, v23
    v_mfma_f32_16x16x32_bf16 a[12:15], a[104:107], v[124:127], a[12:15]
    v_mfma_f32_16x16x32_bf16 a[16:19], a[108:111], v[112:115], a[16:19]
    ds_read_b128 a[104:107], v26
    v_mad_u32_u24 v27, v142, s59, v6
    v_mfma_f32_16x16x32_bf16 a[20:23], a[108:111], v[116:119], a[20:23]
    v_mov_b32_dpp v50, v201 row_ror:8 row_mask:0xf bank_mask:0xf
    v_perm_b32 v101, v49, v197, v23
    v_mfma_f32_16x16x32_bf16 a[24:27], a[108:111], v[120:123], a[24:27]
    v_mov_b32_dpp v51, v205 row_ror:8 row_mask:0xf bank_mask:0xf
    v_perm_b32 v102, v50, v201, v23
    v_mfma_f32_16x16x32_bf16 a[28:31], a[108:111], v[124:127], a[28:31]
    s_waitcnt lgkmcnt(3)
    v_mfma_f32_16x16x32_bf16 a[32:35], a[112:115], v[112:115], a[32:35]
    ds_read_b128 a[108:111], v27
    v_mad_u32_u24 v28, v146, s59, v6
    v_mfma_f32_16x16x32_bf16 a[36:39], a[112:115], v[116:119], a[36:39]
    v_mov_b32_dpp v48, v194 row_ror:8 row_mask:0xf bank_mask:0xf
    v_perm_b32 v103, v51, v205, v23
    v_mfma_f32_16x16x32_bf16 a[40:43], a[112:115], v[120:123], a[40:43]
    v_mov_b32_dpp v49, v198 row_ror:8 row_mask:0xf bank_mask:0xf
    v_perm_b32 v104, v48, v194, v23
    v_mfma_f32_16x16x32_bf16 a[44:47], a[112:115], v[124:127], a[44:47]
    v_mfma_f32_16x16x32_bf16 a[48:51], a[116:119], v[112:115], a[48:51]
    ds_read_b128 a[112:115], v28
    v_mad_u32_u24 v29, v150, s59, v6
    v_mfma_f32_16x16x32_bf16 a[52:55], a[116:119], v[116:119], a[52:55]
    v_mov_b32_dpp v50, v202 row_ror:8 row_mask:0xf bank_mask:0xf
    v_perm_b32 v105, v49, v198, v23
    v_mfma_f32_16x16x32_bf16 a[56:59], a[116:119], v[120:123], a[56:59]
    v_mov_b32_dpp v51, v206 row_ror:8 row_mask:0xf bank_mask:0xf
    v_perm_b32 v106, v50, v202, v23
    v_mfma_f32_16x16x32_bf16 a[60:63], a[116:119], v[124:127], a[60:63]
    v_mfma_f32_16x16x32_bf16 a[64:67], a[120:123], v[112:115], a[64:67]
    ds_read_b128 a[116:119], v29
    v_mad_u32_u24 v30, v154, s59, v6
    v_mfma_f32_16x16x32_bf16 a[68:71], a[120:123], v[116:119], a[68:71]
    v_mov_b32_dpp v48, v195 row_ror:8 row_mask:0xf bank_mask:0xf
    v_perm_b32 v107, v51, v206, v23
    v_mfma_f32_16x16x32_bf16 a[72:75], a[120:123], v[120:123], a[72:75]
    v_mov_b32_dpp v49, v199 row_ror:8 row_mask:0xf bank_mask:0xf
    v_perm_b32 v108, v48, v195, v23
    v_mfma_f32_16x16x32_bf16 a[76:79], a[120:123], v[124:127], a[76:79]
    v_mfma_f32_16x16x32_bf16 a[80:83], a[124:127], v[112:115], a[80:83]
    ds_read_b128 a[120:123], v30
    v_mad_u32_u24 v31, v158, s59, v6
    v_mfma_f32_16x16x32_bf16 a[84:87], a[124:127], v[116:119], a[84:87]
    v_mov_b32_dpp v50, v203 row_ror:8 row_mask:0xf bank_mask:0xf
    v_perm_b32 v109, v49, v199, v23
    v_mfma_f32_16x16x32_bf16 a[88:91], a[124:127], v[120:123], a[88:91]
    v_mov_b32_dpp v51, v207 row_ror:8 row_mask:0xf bank_mask:0xf
    v_perm_b32 v110, v50, v203, v23
    v_mfma_f32_16x16x32_bf16 a[92:95], a[124:127], v[124:127], a[92:95]
    v_perm_b32 v111, v51, v207, v23
    s_waitcnt vmcnt(4) lgkmcnt(3)
    v_mfma_f32_16x16x32_bf16 v[64:67], a[96:99], v[96:99], v[64:67]
    ds_read_b128 a[124:127], v31
    v_mad_u32_u24 v24, v131, s59, v6
    v_mfma_f32_16x16x32_bf16 v[68:71], a[96:99], v[100:103], v[68:71]
    v_mov_b32_dpp v48, v208 row_ror:8 row_mask:0xf bank_mask:0xf
    v_mfma_f32_16x16x32_bf16 v[72:75], a[96:99], v[104:107], v[72:75]
    v_mov_b32_dpp v49, v212 row_ror:8 row_mask:0xf bank_mask:0xf
    v_perm_b32 v112, v48, v208, v23
    v_mfma_f32_16x16x32_bf16 v[76:79], a[96:99], v[108:111], v[76:79]
    ds_read_b32 v128, v40
    v_mfma_f32_16x16x32_bf16 v[80:83], a[100:103], v[96:99], v[80:83]
    ds_read_b128 a[96:99], v24
    v_mad_u32_u24 v25, v135, s59, v6
    v_mfma_f32_16x16x32_bf16 v[84:87], a[100:103], v[100:103], v[84:87]
    v_mov_b32_dpp v50, v216 row_ror:8 row_mask:0xf bank_mask:0xf
    v_perm_b32 v113, v49, v212, v23
    v_mfma_f32_16x16x32_bf16 v[88:91], a[100:103], v[104:107], v[88:91]
    v_mov_b32_dpp v51, v220 row_ror:8 row_mask:0xf bank_mask:0xf
    v_perm_b32 v114, v50, v216, v23
    v_mfma_f32_16x16x32_bf16 v[92:95], a[100:103], v[108:111], v[92:95]
    ds_read_b32 v132, v41
    v_mfma_f32_16x16x32_bf16 a[0:3], a[104:107], v[96:99], a[0:3]
    ds_read_b128 a[100:103], v25
    v_mad_u32_u24 v26, v139, s59, v6
    v_mfma_f32_16x16x32_bf16 a[4:7], a[104:107], v[100:103], a[4:7]
    v_mov_b32_dpp v48, v209 row_ror:8 row_mask:0xf bank_mask:0xf
    v_perm_b32 v115, v51, v220, v23
    v_mfma_f32_16x16x32_bf16 a[8:11], a[104:107], v[104:107], a[8:11]
    v_mov_b32_dpp v49, v213 row_ror:8 row_mask:0xf bank_mask:0xf
    v_perm_b32 v116, v48, v209, v23
    v_mfma_f32_16x16x32_bf16 a[12:15], a[104:107], v[108:111], a[12:15]
    ds_read_b32 v136, v42
    v_mfma_f32_16x16x32_bf16 a[16:19], a[108:111], v[96:99], a[16:19]
    ds_read_b128 a[104:107], v26
    v_mad_u32_u24 v27, v143, s59, v6
    v_mfma_f32_16x16x32_bf16 a[20:23], a[108:111], v[100:103], a[20:23]
    v_mov_b32_dpp v50, v217 row_ror:8 row_mask:0xf bank_mask:0xf
    v_perm_b32 v117, v49, v213, v23
    v_mfma_f32_16x16x32_bf16 a[24:27], a[108:111], v[104:107], a[24:27]
    v_mov_b32_dpp v51, v221 row_ror:8 row_mask:0xf bank_mask:0xf
    v_perm_b32 v118, v50, v217, v23
    v_mfma_f32_16x16x32_bf16 a[28:31], a[108:111], v[108:111], a[28:31]
    ds_read_b32 v140, v43
    s_waitcnt lgkmcnt(7)
    v_mfma_f32_16x16x32_bf16 a[32:35], a[112:115], v[96:99], a[32:35]
    ds_read_b128 a[108:111], v27
    v_mad_u32_u24 v28, v147, s59, v6
    v_mfma_f32_16x16x32_bf16 a[36:39], a[112:115], v[100:103], a[36:39]
    v_mov_b32_dpp v48, v210 row_ror:8 row_mask:0xf bank_mask:0xf
    v_perm_b32 v119, v51, v221, v23
    v_mfma_f32_16x16x32_bf16 a[40:43], a[112:115], v[104:107], a[40:43]
    v_mov_b32_dpp v49, v214 row_ror:8 row_mask:0xf bank_mask:0xf
    v_perm_b32 v120, v48, v210, v23
    v_mfma_f32_16x16x32_bf16 a[44:47], a[112:115], v[108:111], a[44:47]
    ds_read_b32 v144, v44
    v_mfma_f32_16x16x32_bf16 a[48:51], a[116:119], v[96:99], a[48:51]
    ds_read_b128 a[112:115], v28
    v_mad_u32_u24 v29, v151, s59, v6
    v_mfma_f32_16x16x32_bf16 a[52:55], a[116:119], v[100:103], a[52:55]
    v_mov_b32_dpp v50, v218 row_ror:8 row_mask:0xf bank_mask:0xf
    v_perm_b32 v121, v49, v214, v23
    v_mfma_f32_16x16x32_bf16 a[56:59], a[116:119], v[104:107], a[56:59]
    v_mov_b32_dpp v51, v222 row_ror:8 row_mask:0xf bank_mask:0xf
    v_perm_b32 v122, v50, v218, v23
    v_mfma_f32_16x16x32_bf16 a[60:63], a[116:119], v[108:111], a[60:63]
    ds_read_b32 v148, v45
    v_mfma_f32_16x16x32_bf16 a[64:67], a[120:123], v[96:99], a[64:67]
    ds_read_b128 a[116:119], v29
    v_mad_u32_u24 v30, v155, s59, v6
    v_mfma_f32_16x16x32_bf16 a[68:71], a[120:123], v[100:103], a[68:71]
    v_mov_b32_dpp v48, v211 row_ror:8 row_mask:0xf bank_mask:0xf
    v_perm_b32 v123, v51, v222, v23
    v_mfma_f32_16x16x32_bf16 a[72:75], a[120:123], v[104:107], a[72:75]
    v_mov_b32_dpp v49, v215 row_ror:8 row_mask:0xf bank_mask:0xf
    v_perm_b32 v124, v48, v211, v23
    v_mfma_f32_16x16x32_bf16 a[76:79], a[120:123], v[108:111], a[76:79]
    ds_read_b32 v152, v46
    v_mfma_f32_16x16x32_bf16 a[80:83], a[124:127], v[96:99], a[80:83]
    ds_read_b128 a[120:123], v30
    v_mad_u32_u24 v31, v159, s59, v6
    v_mfma_f32_16x16x32_bf16 a[84:87], a[124:127], v[100:103], a[84:87]
    v_mov_b32_dpp v50, v219 row_ror:8 row_mask:0xf bank_mask:0xf
    v_perm_b32 v125, v49, v215, v23
    v_mfma_f32_16x16x32_bf16 a[88:91], a[124:127], v[104:107], a[88:91]
    v_mov_b32_dpp v51, v223 row_ror:8 row_mask:0xf bank_mask:0xf
    v_perm_b32 v126, v50, v219, v23
    v_mfma_f32_16x16x32_bf16 a[92:95], a[124:127], v[108:111], a[92:95]
    ds_read_b32 v156, v47
    v_perm_b32 v127, v51, v223, v23
    s_waitcnt vmcnt(0) lgkmcnt(7)
    v_mfma_f32_16x16x32_bf16 v[64:67], a[96:99], v[112:115], v[64:67]
    ds_read_b128 a[124:127], v31
    v_mad_u32_u24 v24, v128, s59, v6
    v_mfma_f32_16x16x32_bf16 v[68:71], a[96:99], v[116:119], v[68:71]
    v_mov_b32_dpp v48, v160 row_ror:8 row_mask:0xf bank_mask:0xf
    v_mfma_f32_16x16x32_bf16 v[72:75], a[96:99], v[120:123], v[72:75]
    v_mov_b32_dpp v49, v164 row_ror:8 row_mask:0xf bank_mask:0xf
    v_perm_b32 v96, v48, v160, v23
    v_mfma_f32_16x16x32_bf16 v[76:79], a[96:99], v[124:127], v[76:79]
    v_mfma_f32_16x16x32_bf16 v[80:83], a[100:103], v[112:115], v[80:83]
    ds_read_b128 a[96:99], v24
    v_mad_u32_u24 v25, v132, s59, v6
    v_mfma_f32_16x16x32_bf16 v[84:87], a[100:103], v[116:119], v[84:87]
    v_mov_b32_dpp v50, v168 row_ror:8 row_mask:0xf bank_mask:0xf
    v_perm_b32 v97, v49, v164, v23
    v_mfma_f32_16x16x32_bf16 v[88:91], a[100:103], v[120:123], v[88:91]
    v_mov_b32_dpp v51, v172 row_ror:8 row_mask:0xf bank_mask:0xf
    v_perm_b32 v98, v50, v168, v23
    v_mfma_f32_16x16x32_bf16 v[92:95], a[100:103], v[124:127], v[92:95]
    v_mfma_f32_16x16x32_bf16 a[0:3], a[104:107], v[112:115], a[0:3]
    ds_read_b128 a[100:103], v25
    v_mad_u32_u24 v26, v136, s59, v6
    v_mfma_f32_16x16x32_bf16 a[4:7], a[104:107], v[116:119], a[4:7]
    v_mov_b32_dpp v48, v161 row_ror:8 row_mask:0xf bank_mask:0xf
    v_perm_b32 v99, v51, v172, v23
    v_mfma_f32_16x16x32_bf16 a[8:11], a[104:107], v[120:123], a[8:11]
    v_mov_b32_dpp v49, v165 row_ror:8 row_mask:0xf bank_mask:0xf
    v_perm_b32 v100, v48, v161, v23
    v_mfma_f32_16x16x32_bf16 a[12:15], a[104:107], v[124:127], a[12:15]
    v_mfma_f32_16x16x32_bf16 a[16:19], a[108:111], v[112:115], a[16:19]
    ds_read_b128 a[104:107], v26
    v_mad_u32_u24 v27, v140, s59, v6
    v_mfma_f32_16x16x32_bf16 a[20:23], a[108:111], v[116:119], a[20:23]
    v_mov_b32_dpp v50, v169 row_ror:8 row_mask:0xf bank_mask:0xf
    v_perm_b32 v101, v49, v165, v23
    v_mfma_f32_16x16x32_bf16 a[24:27], a[108:111], v[120:123], a[24:27]
    v_mov_b32_dpp v51, v173 row_ror:8 row_mask:0xf bank_mask:0xf
    v_perm_b32 v102, v50, v169, v23
    v_mfma_f32_16x16x32_bf16 a[28:31], a[108:111], v[124:127], a[28:31]
    s_waitcnt lgkmcnt(3)
    v_mfma_f32_16x16x32_bf16 a[32:35], a[112:115], v[112:115], a[32:35]
    ds_read_b128 a[108:111], v27
    v_mad_u32_u24 v28, v144, s59, v6
    v_mfma_f32_16x16x32_bf16 a[36:39], a[112:115], v[116:119], a[36:39]
    v_mov_b32_dpp v48, v162 row_ror:8 row_mask:0xf bank_mask:0xf
    v_perm_b32 v103, v51, v173, v23
    v_mfma_f32_16x16x32_bf16 a[40:43], a[112:115], v[120:123], a[40:43]
    v_mov_b32_dpp v49, v166 row_ror:8 row_mask:0xf bank_mask:0xf
    v_perm_b32 v104, v48, v162, v23
    v_mfma_f32_16x16x32_bf16 a[44:47], a[112:115], v[124:127], a[44:47]
    v_mfma_f32_16x16x32_bf16 a[48:51], a[116:119], v[112:115], a[48:51]
    ds_read_b128 a[112:115], v28
    v_mad_u32_u24 v29, v148, s59, v6
    v_mfma_f32_16x16x32_bf16 a[52:55], a[116:119], v[116:119], a[52:55]
    v_mov_b32_dpp v50, v170 row_ror:8 row_mask:0xf bank_mask:0xf
    v_perm_b32 v105, v49, v166, v23
    v_mfma_f32_16x16x32_bf16 a[56:59], a[116:119], v[120:123], a[56:59]
    v_mov_b32_dpp v51, v174 row_ror:8 row_mask:0xf bank_mask:0xf
    v_perm_b32 v106, v50, v170, v23
    v_mfma_f32_16x16x32_bf16 a[60:63], a[116:119], v[124:127], a[60:63]
    v_mfma_f32_16x16x32_bf16 a[64:67], a[120:123], v[112:115], a[64:67]
    ds_read_b128 a[116:119], v29
    v_mad_u32_u24 v30, v152, s59, v6
    v_mfma_f32_16x16x32_bf16 a[68:71], a[120:123], v[116:119], a[68:71]
    v_mov_b32_dpp v48, v163 row_ror:8 row_mask:0xf bank_mask:0xf
    v_perm_b32 v107, v51, v174, v23
    v_mfma_f32_16x16x32_bf16 a[72:75], a[120:123], v[120:123], a[72:75]
    v_mov_b32_dpp v49, v167 row_ror:8 row_mask:0xf bank_mask:0xf
    v_perm_b32 v108, v48, v163, v23
    v_mfma_f32_16x16x32_bf16 a[76:79], a[120:123], v[124:127], a[76:79]
    v_mfma_f32_16x16x32_bf16 a[80:83], a[124:127], v[112:115], a[80:83]
    ds_read_b128 a[120:123], v30
    v_mad_u32_u24 v31, v156, s59, v6
    v_mfma_f32_16x16x32_bf16 a[84:87], a[124:127], v[116:119], a[84:87]
    v_mov_b32_dpp v50, v171 row_ror:8 row_mask:0xf bank_mask:0xf
    v_perm_b32 v109, v49, v167, v23
    v_mfma_f32_16x16x32_bf16 a[88:91], a[124:127], v[120:123], a[88:91]
    v_mov_b32_dpp v51, v175 row_ror:8 row_mask:0xf bank_mask:0xf
    v_perm_b32 v110, v50, v171, v23
    v_mfma_f32_16x16x32_bf16 a[92:95], a[124:127], v[124:127], a[92:95]
    v_perm_b32 v111, v51, v175, v23
    s_waitcnt lgkmcnt(3)
    s_waitcnt lgkmcnt(0)
    v_mfma_f32_16x16x32_bf16 a[0:3], a[104:107], v[96:99], a[0:3]
    ds_read_b128 a[124:127], v31
    v_mfma_f32_16x16x32_bf16 a[4:7], a[104:107], v[100:103], a[4:7]
    v_mfma_f32_16x16x32_bf16 a[8:11], a[104:107], v[104:107], a[8:11]
    v_mfma_f32_16x16x32_bf16 a[12:15], a[104:107], v[108:111], a[12:15]
    v_mfma_f32_16x16x32_bf16 a[32:35], a[112:115], v[96:99], a[32:35]
    v_mfma_f32_16x16x32_bf16 a[36:39], a[112:115], v[100:103], a[36:39]
    v_mfma_f32_16x16x32_bf16 a[40:43], a[112:115], v[104:107], a[40:43]
    v_mfma_f32_16x16x32_bf16 a[44:47], a[112:115], v[108:111], a[44:47]
    v_mfma_f32_16x16x32_bf16 a[64:67], a[120:123], v[96:99], a[64:67]
    v_mfma_f32_16x16x32_bf16 a[68:71], a[120:123], v[100:103], a[68:71]
    v_mfma_f32_16x16x32_bf16 a[72:75], a[120:123], v[104:107], a[72:75]
    ds_write_b128 v53, a[0:3] offset:49152
    v_mfma_f32_16x16x32_bf16 a[76:79], a[120:123], v[108:111], a[76:79]
    ds_write_b128 v53, a[4:7] offset:50176
    v_mfma_f32_16x16x32_bf16 v[64:67], a[96:99], v[96:99], v[64:67]
    ds_write_b128 v53, a[8:11] offset:51200
    v_mfma_f32_16x16x32_bf16 v[68:71], a[96:99], v[100:103], v[68:71]
    ds_write_b128 v53, a[12:15] offset:52224
    v_mfma_f32_16x16x32_bf16 v[72:75], a[96:99], v[104:107], v[72:75]
    ds_write_b128 v54, a[32:35] offset:49152
    v_mfma_f32_16x16x32_bf16 v[76:79], a[96:99], v[108:111], v[76:79]
    ds_write_b128 v54, a[36:39] offset:50176
    v_mfma_f32_16x16x32_bf16 v[80:83], a[100:103], v[96:99], v[80:83]
    ds_write_b128 v54, a[40:43] offset:51200
    v_mfma_f32_16x16x32_bf16 v[84:87], a[100:103], v[100:103], v[84:87]
    ds_write_b128 v54, a[44:47] offset:52224
    v_mfma_f32_16x16x32_bf16 v[88:91], a[100:103], v[104:107], v[88:91]
    ds_write_b128 v55, a[64:67] offset:49152
    v_mfma_f32_16x16x32_bf16 v[92:95], a[100:103], v[108:111], v[92:95]
    ds_write_b128 v55, a[68:71] offset:50176
    v_mfma_f32_16x16x32_bf16 a[16:19], a[108:111], v[96:99], a[16:19]
    ds_write_b128 v55, a[72:75] offset:51200
    v_mfma_f32_16x16x32_bf16 a[20:23], a[108:111], v[100:103], a[20:23]
    ds_write_b128 v55, a[76:79] offset:52224
    v_mfma_f32_16x16x32_bf16 a[24:27], a[108:111], v[104:107], a[24:27]
    v_mfma_f32_16x16x32_bf16 a[28:31], a[108:111], v[108:111], a[28:31]
    v_mfma_f32_16x16x32_bf16 a[48:51], a[116:119], v[96:99], a[48:51]
    v_mfma_f32_16x16x32_bf16 a[52:55], a[116:119], v[100:103], a[52:55]
    v_mfma_f32_16x16x32_bf16 a[56:59], a[116:119], v[104:107], a[56:59]
    v_mfma_f32_16x16x32_bf16 a[60:63], a[116:119], v[108:111], a[60:63]
    s_waitcnt lgkmcnt(12)
    v_mfma_f32_16x16x32_bf16 a[80:83], a[124:127], v[96:99], a[80:83]
    v_mfma_f32_16x16x32_bf16 a[84:87], a[124:127], v[100:103], a[84:87]
    v_mfma_f32_16x16x32_bf16 a[88:91], a[124:127], v[104:107], a[88:91]
    v_mfma_f32_16x16x32_bf16 a[92:95], a[124:127], v[108:111], a[92:95]
    s_waitcnt lgkmcnt(0)
    s_barrier
    ds_read_b128 v[96:99], v56 offset:49152
    ds_read_b128 v[128:131], v56 offset:53248
    ds_read_b128 v[160:163], v56 offset:57344
    ds_read_b128 v[100:103], v56 offset:50176
    ds_read_b128 v[132:135], v56 offset:54272
    ds_read_b128 v[164:167], v56 offset:58368
    ds_read_b128 v[104:107], v56 offset:51200
    ds_read_b128 v[136:139], v56 offset:55296
    ds_read_b128 v[168:171], v56 offset:59392
    ds_read_b128 v[108:111], v56 offset:52224
    ds_read_b128 v[140:143], v56 offset:56320
    ds_read_b128 v[172:175], v56 offset:60416
    s_waitcnt lgkmcnt(9)
    ds_write_b128 v53, a[16:19] offset:0
    ds_write_b128 v53, a[20:23] offset:1024
    ds_write_b128 v53, a[24:27] offset:2048
    v_pk_add_f32 v[64:65], v[64:65], v[96:97]
    v_pk_add_f32 v[66:67], v[66:67], v[98:99]
    v_pk_add_f32 v[64:65], v[64:65], v[128:129]
    v_pk_add_f32 v[66:67], v[66:67], v[130:131]
    v_pk_add_f32 v[64:65], v[64:65], v[160:161]
    v_pk_add_f32 v[66:67], v[66:67], v[162:163]
    buffer_store_dwordx4 v[64:67], v52, s[16:19], s72 offen offset:0 sc1
    s_waitcnt lgkmcnt(9)
    ds_write_b128 v53, a[28:31] offset:3072
    ds_write_b128 v54, a[48:51] offset:0
    ds_write_b128 v54, a[52:55] offset:1024
    v_pk_add_f32 v[68:69], v[68:69], v[100:101]
    v_pk_add_f32 v[70:71], v[70:71], v[102:103]
    v_pk_add_f32 v[68:69], v[68:69], v[132:133]
    v_pk_add_f32 v[70:71], v[70:71], v[134:135]
    v_pk_add_f32 v[68:69], v[68:69], v[164:165]
    v_pk_add_f32 v[70:71], v[70:71], v[166:167]
    buffer_store_dwordx4 v[68:71], v52, s[16:19], s72 offen offset:256 sc1
    s_waitcnt lgkmcnt(9)
    ds_write_b128 v54, a[56:59] offset:2048
    ds_write_b128 v54, a[60:63] offset:3072
    ds_write_b128 v55, a[80:83] offset:0
    v_pk_add_f32 v[72:73], v[72:73], v[104:105]
    v_pk_add_f32 v[74:75], v[74:75], v[106:107]
    v_pk_add_f32 v[72:73], v[72:73], v[136:137]
    v_pk_add_f32 v[74:75], v[74:75], v[138:139]
    v_pk_add_f32 v[72:73], v[72:73], v[168:169]
    v_pk_add_f32 v[74:75], v[74:75], v[170:171]
    buffer_store_dwordx4 v[72:75], v52, s[16:19], s72 offen offset:512 sc1
    s_waitcnt lgkmcnt(9)
    ds_write_b128 v55, a[84:87] offset:1024
    ds_write_b128 v55, a[88:91] offset:2048
    ds_write_b128 v55, a[92:95] offset:3072
    v_pk_add_f32 v[76:77], v[76:77], v[108:109]
    v_pk_add_f32 v[78:79], v[78:79], v[110:111]
    v_pk_add_f32 v[76:77], v[76:77], v[140:141]
    v_pk_add_f32 v[78:79], v[78:79], v[142:143]
    v_pk_add_f32 v[76:77], v[76:77], v[172:173]
    v_pk_add_f32 v[78:79], v[78:79], v[174:175]
    buffer_store_dwordx4 v[76:79], v52, s[16:19], s72 offen offset:768 sc1
    s_waitcnt lgkmcnt(0)
    s_barrier
    ds_read_b128 v[112:115], v56 offset:0
    ds_read_b128 v[144:147], v56 offset:4096
    ds_read_b128 v[176:179], v56 offset:8192
    ds_read_b128 v[116:119], v56 offset:1024
    ds_read_b128 v[148:151], v56 offset:5120
    ds_read_b128 v[180:183], v56 offset:9216
    ds_read_b128 v[120:123], v56 offset:2048
    ds_read_b128 v[152:155], v56 offset:6144
    ds_read_b128 v[184:187], v56 offset:10240
    ds_read_b128 v[124:127], v56 offset:3072
    ds_read_b128 v[156:159], v56 offset:7168
    ds_read_b128 v[188:191], v56 offset:11264
    v_readfirstlane_b32 s55, v22
    s_mov_b32 s63, 0
    s_mov_b32 s54, 0xffff0000
    s_nop 1
    s_cmp_lt_i32 s55, 0
    s_cbranch_scc0 L_NONCE_SLOW
L_NONCEOK:
    s_waitcnt lgkmcnt(9)
    v_pk_add_f32 v[80:81], v[80:81], v[112:113]
    v_pk_add_f32 v[82:83], v[82:83], v[114:115]
    v_pk_add_f32 v[80:81], v[80:81], v[144:145]
    v_pk_add_f32 v[82:83], v[82:83], v[146:147]
    v_pk_add_f32 v[80:81], v[80:81], v[176:177]
    v_pk_add_f32 v[82:83], v[82:83], v[178:179]
    buffer_store_dwordx4 v[80:83], v52, s[16:19], s73 offen offset:0 sc1
    s_waitcnt lgkmcnt(6)
    v_pk_add_f32 v[84:85], v[84:85], v[116:117]
    v_pk_add_f32 v[86:87], v[86:87], v[118:119]
    v_pk_add_f32 v[84:85], v[84:85], v[148:149]
    v_pk_add_f32 v[86:87], v[86:87], v[150:151]
    v_pk_add_f32 v[84:85], v[84:85], v[180:181]
    v_pk_add_f32 v[86:87], v[86:87], v[182:183]
    buffer_store_dwordx4 v[84:87], v52, s[16:19], s73 offen offset:256 sc1
    s_waitcnt lgkmcnt(3)
    v_pk_add_f32 v[88:89], v[88:89], v[120:121]
    v_pk_add_f32 v[90:91], v[90:91], v[122:123]
    v_pk_add_f32 v[88:89], v[88:89], v[152:153]
    v_pk_add_f32 v[90:91], v[90:91], v[154:155]
    v_pk_add_f32 v[88:89], v[88:89], v[184:185]
    v_pk_add_f32 v[90:91], v[90:91], v[186:187]
    buffer_store_dwordx4 v[88:91], v52, s[16:19], s73 offen offset:512 sc1
    s_waitcnt lgkmcnt(0)
    v_pk_add_f32 v[92:93], v[92:93], v[124:125]
    v_pk_add_f32 v[94:95], v[94:95], v[126:127]
    v_pk_add_f32 v[92:93], v[92:93], v[156:157]
    v_pk_add_f32 v[94:95], v[94:95], v[158:159]
    v_pk_add_f32 v[92:93], v[92:93], v[188:189]
    v_pk_add_f32 v[94:95], v[94:95], v[190:191]
    buffer_store_dwordx4 v[92:95], v52, s[16:19], s73 offen offset:768 sc1
    s_waitcnt vmcnt(4)
    buffer_store_dword v22, v59, s[16:19], s99 offen sc1
    v_lshlrev_b32 v14, 16, v14
    v_lshlrev_b32 v15, 16, v15
    v_lshlrev_b32 v16, 16, v16
    v_lshlrev_b32 v17, 16, v17
    v_lshlrev_b32 v18, 16, v18
    v_lshlrev_b32 v19, 16, v19
    v_cmp_gt_u32 vcc, 13, v2
    v_mul_f32 v18, v18, v19
    v_lshlrev_b32 v20, 16, v20
    v_lshlrev_b32 v21, 16, v21
    v_cndmask_b32 v18, 0, v18, vcc
    s_nop 1
    v_add_f32_dpp v18, v18, v18 row_shr:1 row_mask:0xf bank_mask:0xf
    s_nop 1
    v_add_f32_dpp v18, v18, v18 row_shr:2 row_mask:0xf bank_mask:0xf
    s_nop 1
    v_add_f32_dpp v18, v18, v18 row_shr:4 row_mask:0xf bank_mask:0xf
    s_nop 1
    v_add_f32_dpp v18, v18, v18 row_shr:8 row_mask:0xf bank_mask:0xf
    s_nop 1
    v_cvt_pk_bf16_f32 v18, v18, v18
    v_and_b32 v18, s54, v18
    v_add_f32 v18, v18, v20
    v_cvt_pk_bf16_f32 v18, v18, v18
    v_and_b32 v18, s54, v18
    s_waitcnt vmcnt(1)
    buffer_store_dword v22, v59, s[16:19], s99 offen offset:2048 sc1
    v_mov_b32 v155, 0
    buffer_atomic_or v155, v58, s[16:19], s98 offen sc0 sc1
    s_sleep 4
L_IND:
    v_mov_b32 v156, 0
    buffer_atomic_or v156, v58, s[16:19], s98 offen sc0 sc1
    s_waitcnt vmcnt(1)
    v_cmp_ne_u32 vcc, v155, v22
    s_and_b64 vcc, vcc, 0xff
    s_cbranch_vccz L_INDOK
    v_mov_b32 v155, 0
    buffer_atomic_or v155, v58, s[16:19], s98 offen sc0 sc1
    s_waitcnt vmcnt(1)
    v_cmp_ne_u32 vcc, v156, v22
    s_and_b64 vcc, vcc, 0xff
    s_cbranch_vccz L_INDOK
    s_add_u32 s63, s63, 1
    s_cmp_gt_u32 s63, 100000
    s_cbranch_scc0 L_IND
L_INDOK:
    buffer_load_dwordx4 v[96:99], v7, s[16:19], s61 offen offset:0 sc1
    buffer_load_dwordx4 v[100:103], v7, s[16:19], s61 offen offset:1024 sc1
    buffer_load_dwordx4 v[104:107], v7, s[16:19], s61 offen offset:2048 sc1
    buffer_load_dwordx4 v[108:111], v7, s[16:19], s61 offen offset:3072 sc1
    buffer_load_dwordx4 v[112:115], v7, s[16:19], s62 offen offset:0 sc1
    buffer_load_dwordx4 v[116:119], v7, s[16:19], s62 offen offset:1024 sc1
    buffer_load_dwordx4 v[120:123], v7, s[16:19], s62 offen offset:2048 sc1
    buffer_load_dwordx4 v[124:127], v7, s[16:19], s62 offen offset:3072 sc1
    s_waitcnt vmcnt(4)
    v_pk_add_f32 v[136:137], v[96:97], v[100:101]
    v_pk_add_f32 v[138:139], v[98:99], v[102:103]
    v_pk_add_f32 v[136:137], v[136:137], v[104:105]
    v_pk_add_f32 v[138:139], v[138:139], v[106:107]
    v_pk_add_f32 v[136:137], v[136:137], v[108:109]
    v_pk_add_f32 v[138:139], v[138:139], v[110:111]
    v_cvt_pk_bf16_f32 v136, v136, v136
    v_cvt_pk_bf16_f32 v137, v137, v137
    v_cvt_pk_bf16_f32 v138, v138, v138
    v_cvt_pk_bf16_f32 v139, v139, v139
    v_and_b32 v136, s54, v136
    v_and_b32 v137, s54, v137
    v_and_b32 v138, s54, v138
    v_and_b32 v139, s54, v139
    v_add_f32 v136, v136, v14
    v_add_f32 v137, v137, v14
    v_add_f32 v138, v138, v14
    v_add_f32 v139, v139, v14
    v_cvt_pk_bf16_f32 v136, v136, v136
    v_cvt_pk_bf16_f32 v137, v137, v137
    v_cvt_pk_bf16_f32 v138, v138, v138
    v_cvt_pk_bf16_f32 v139, v139, v139
    v_and_b32 v136, s54, v136
    v_and_b32 v137, s54, v137
    v_and_b32 v138, s54, v138
    v_and_b32 v139, s54, v139
    v_cmp_lt_f32 s[72:73], 0, v136
    v_cmp_lt_f32 s[74:75], 0, v137
    s_nop 0
    v_cndmask_b32 v156, 0, 1.0, s[72:73]
    v_cndmask_b32 v157, 0, 1.0, s[74:75]
    v_cmp_lt_f32 s[72:73], 0, v138
    v_cmp_lt_f32 s[74:75], 0, v139
    s_nop 0
    v_cndmask_b32 v158, 0, 1.0, s[72:73]
    v_cndmask_b32 v159, 0, 1.0, s[74:75]
    v_mul_f32 v136, v136, v156
    v_mul_f32 v137, v137, v157
    v_mul_f32 v138, v138, v158
    v_mul_f32 v139, v139, v159
    v_mul_f32 v144, v136, v16
    v_mul_f32 v145, v137, v16
    v_mul_f32 v146, v138, v16
    v_mul_f32 v147, v139, v16
    s_waitcnt vmcnt(0)
    v_pk_add_f32 v[140:141], v[112:113], v[116:117]
    v_pk_add_f32 v[142:143], v[114:115], v[118:119]
    v_pk_add_f32 v[140:141], v[140:141], v[120:121]
    v_pk_add_f32 v[142:143], v[142:143], v[122:123]
    v_pk_add_f32 v[140:141], v[140:141], v[124:125]
    v_pk_add_f32 v[142:143], v[142:143], v[126:127]
    v_cvt_pk_bf16_f32 v140, v140, v140
    v_cvt_pk_bf16_f32 v141, v141, v141
    v_cvt_pk_bf16_f32 v142, v142, v142
    v_cvt_pk_bf16_f32 v143, v143, v143
    v_and_b32 v140, s54, v140
    v_and_b32 v141, s54, v141
    v_and_b32 v142, s54, v142
    v_and_b32 v143, s54, v143
    v_add_f32 v140, v140, v15
    v_add_f32 v141, v141, v15
    v_add_f32 v142, v142, v15
    v_add_f32 v143, v143, v15
    v_cvt_pk_bf16_f32 v140, v140, v140
    v_cvt_pk_bf16_f32 v141, v141, v141
    v_cvt_pk_bf16_f32 v142, v142, v142
    v_cvt_pk_bf16_f32 v143, v143, v143
    v_and_b32 v140, s54, v140
    v_and_b32 v141, s54, v141
    v_and_b32 v142, s54, v142
    v_and_b32 v143, s54, v143
    v_cmp_lt_f32 s[72:73], 0, v140
    v_cmp_lt_f32 s[74:75], 0, v141
    s_nop 0
    v_cndmask_b32 v156, 0, 1.0, s[72:73]
    v_cndmask_b32 v157, 0, 1.0, s[74:75]
    v_cmp_lt_f32 s[72:73], 0, v142
    v_cmp_lt_f32 s[74:75], 0, v143
    s_nop 0
    v_cndmask_b32 v158, 0, 1.0, s[72:73]
    v_cndmask_b32 v159, 0, 1.0, s[74:75]
    v_mul_f32 v140, v140, v156
    v_mul_f32 v141, v141, v157
    v_mul_f32 v142, v142, v158
    v_mul_f32 v143, v143, v159
    v_fmac_f32 v144, v140, v17
    v_fmac_f32 v145, v141, v17
    v_fmac_f32 v146, v142, v17
    v_fmac_f32 v147, v143, v17
    v_add_f32_dpp v144, v144, v144 row_shr:1 row_mask:0xf bank_mask:0xf
    v_add_f32_dpp v145, v145, v145 row_shr:1 row_mask:0xf bank_mask:0xf
    v_add_f32_dpp v146, v146, v146 row_shr:1 row_mask:0xf bank_mask:0xf
    v_add_f32_dpp v147, v147, v147 row_shr:1 row_mask:0xf bank_mask:0xf
    v_add_f32_dpp v144, v144, v144 row_shr:2 row_mask:0xf bank_mask:0xf
    v_add_f32_dpp v145, v145, v145 row_shr:2 row_mask:0xf bank_mask:0xf
    v_add_f32_dpp v146, v146, v146 row_shr:2 row_mask:0xf bank_mask:0xf
    v_add_f32_dpp v147, v147, v147 row_shr:2 row_mask:0xf bank_mask:0xf
    v_add_f32_dpp v144, v144, v144 row_shr:4 row_mask:0xf bank_mask:0xf
    v_add_f32_dpp v145, v145, v145 row_shr:4 row_mask:0xf bank_mask:0xf
    v_add_f32_dpp v146, v146, v146 row_shr:4 row_mask:0xf bank_mask:0xf
    v_add_f32_dpp v147, v147, v147 row_shr:4 row_mask:0xf bank_mask:0xf
    v_add_f32_dpp v144, v144, v144 row_shr:8 row_mask:0xf bank_mask:0xf
    v_add_f32_dpp v145, v145, v145 row_shr:8 row_mask:0xf bank_mask:0xf
    v_add_f32_dpp v146, v146, v146 row_shr:8 row_mask:0xf bank_mask:0xf
    v_add_f32_dpp v147, v147, v147 row_shr:8 row_mask:0xf bank_mask:0xf
    v_add_f32_dpp v144, v144, v144 row_bcast:15 row_mask:0xa bank_mask:0xf
    v_add_f32_dpp v145, v145, v145 row_bcast:15 row_mask:0xa bank_mask:0xf
    v_add_f32_dpp v146, v146, v146 row_bcast:15 row_mask:0xa bank_mask:0xf
    v_add_f32_dpp v147, v147, v147 row_bcast:15 row_mask:0xa bank_mask:0xf
    v_add_f32_dpp v144, v144, v144 row_bcast:31 row_mask:0xc bank_mask:0xf
    v_add_f32_dpp v145, v145, v145 row_bcast:31 row_mask:0xc bank_mask:0xf
    v_add_f32_dpp v146, v146, v146 row_bcast:31 row_mask:0xc bank_mask:0xf
    v_add_f32_dpp v147, v147, v147 row_bcast:31 row_mask:0xc bank_mask:0xf
    s_lshl_b32 s52, s3, 4
    s_add_u32 s52, s52, 149504
    v_mov_b32 v148, s52
    s_mov_b64 s[76:77], exec
    s_mov_b32 exec_lo, 0
    s_mov_b32 exec_hi, 0x80000000
    ds_write_b128 v148, v[144:147]
    s_mov_b64 exec, s[76:77]
    v_lshlrev_b32 v149, 2, v3
    v_add_u32 v149, 149504, v149
    s_waitcnt lgkmcnt(0)
    s_barrier
    s_cmp_lg_u32 s3, 0
    s_cbranch_scc1 L_TS
    ds_read_b32 v144, v149 offset:0
    ds_read_b32 v145, v149 offset:16
    ds_read_b32 v146, v149 offset:32
    ds_read_b32 v147, v149 offset:48
    s_waitcnt lgkmcnt(0)
    v_add_f32 v144, v144, v145
    v_add_f32 v146, v146, v147
    v_add_f32 v144, v144, v146
    v_cvt_pk_bf16_f32 v144, v144, v144
    v_and_b32 v144, s54, v144
    v_add_f32 v144, v144, v21
    v_cvt_pk_bf16_f32 v144, v144, v144
    v_and_b32 v144, s54, v144
    v_add_f32 v144, v144, v18
    v_cvt_pk_bf16_f32 v144, v144, v144
    v_and_b32 v144, s54, v144
    v_mul_f32 v144, 0xbfb8aa3b, v144
    v_exp_f32 v144, v144
    s_nop 0
    v_add_f32 v144, 1.0, v144
    v_rcp_f32 v144, v144
    s_nop 0
    v_cvt_pk_bf16_f32 v144, v144, v144
    s_mov_b32 exec_lo, 0x80008000
    s_mov_b32 exec_hi, 0x80008000
    buffer_store_short v144, v57, s[64:67], 0 offen
    s_mov_b64 exec, -1
L_TS:
    s_branch L_END
L_NONCE_SLOW:
    buffer_load_dword v22, v62, s[20:23], 0 offen sc1
    s_waitcnt vmcnt(0)
    v_readfirstlane_b32 s55, v22
    s_add_u32 s63, s63, 1
    s_nop 3
    s_cmp_gt_u32 s63, 200000
    s_cbranch_scc1 L_NONCEOK
    s_cmp_lt_i32 s55, 0
    s_cbranch_scc0 L_NONCE_SLOW
    s_branch L_NONCEOK
L_END:
    s_endpgm
L_CODE_END:
.section .rodata,"a"
.p2align 6
.amdhsa_kernel standalone__deep_cross_wide_deep__recsys_kernel
  .amdhsa_next_free_vgpr 384
  .amdhsa_next_free_sgpr 102
  .amdhsa_accum_offset 256
  .amdhsa_group_segment_fixed_size 0
  .amdhsa_kernarg_size 96
  .amdhsa_user_sgpr_count 2
  .amdhsa_user_sgpr_kernarg_segment_ptr 1
  .amdhsa_system_sgpr_workgroup_id_x 1
.end_amdhsa_kernel
```
